```python
import torch

def _softmax(x, axis=-1):
    return torch.softmax(x, dim=axis)

def _gelu(x):
    return torch.nn.functional.gelu(x, approximate='tanh')

def _silu(x):
    return torch.nn.functional.silu(x)

def _sigmoid(x):
    return torch.sigmoid(x)

def _layernorm(x, axis=-1, eps=1e-05):
    m = x.mean(dim=axis, keepdim=True)
    v = x.var(dim=axis, keepdim=True, unbiased=False)
    return (x - m) / torch.sqrt(v + eps)

def _scatter_add(tgt, idx, src, axis=0):
    return tgt.clone().index_add_(axis, idx, src)

def _segment_sum(src, seg, n):
    out = torch.zeros((n,) + src.shape[1:], dtype=src.dtype)
    return out.index_add_(0, seg, src)

def _pad(x, pw):
    flat = tuple((v for pair in reversed(pw) for v in pair))
    return torch.nn.functional.pad(x, flat)
kernel_name = 'standalone__tree_speculative_verify_tree_attention_over_candidate_token_tree__decode'

def setup_inputs():

    _w = lambda a: (lambda t: t.to(torch.bfloat16) if t.is_floating_point() else t)(torch.as_tensor(a))
    B, Hq, Hkv, T, C, D = (8, 16, 8, 1, 4096, 256)
    tree_mask = torch.zeros((B, T, T), dtype=float)
    for b in range(B):
        parent = torch.zeros(T, dtype=torch.int64)
        for i in range(1, T):
            parent[i] = int(torch.randint(0, i, (1,)).item())
        for i in range(T):
            j = i
            tree_mask[b, i, j] = 1.0
            while j > 0:
                j = parent[j]
                tree_mask[b, i, j] = 1.0
    return {'q': _w((lambda *s: torch.randn(*s, dtype=torch.bfloat16) * 0.8)(B, Hq, T, D)), 'k_cache': _w((lambda *s: torch.randn(*s, dtype=torch.bfloat16) * 0.8)(B, Hkv, C, D)), 'v_cache': _w((lambda *s: torch.randn(*s, dtype=torch.bfloat16) * 0.05)(B, Hkv, C, D)), 'k_tree': _w((lambda *s: torch.randn(*s, dtype=torch.bfloat16) * 0.8)(B, Hkv, T, D)), 'v_tree': _w((lambda *s: torch.randn(*s, dtype=torch.bfloat16) * 0.05)(B, Hkv, T, D)), 'tree_mask': _w(tree_mask)}

def reference(q, k_cache, v_cache, k_tree, v_tree, tree_mask):
    B, Hq, T, D = q.shape
    Hkv, C = (k_cache.shape[1], k_cache.shape[2])
    rep = Hq // Hkv
    kc = (lambda x, n, axis: torch.repeat_interleave(x, n, dim=axis))(k_cache, rep, axis=1)
    vc = (lambda x, n, axis: torch.repeat_interleave(x, n, dim=axis))(v_cache, rep, axis=1)
    kt = (lambda x, n, axis: torch.repeat_interleave(x, n, dim=axis))(k_tree, rep, axis=1)
    vt = (lambda x, n, axis: torch.repeat_interleave(x, n, dim=axis))(v_tree, rep, axis=1)
    k = torch.concatenate([kc, kt], axis=2)
    v = torch.concatenate([vc, vt], axis=2)
    scale = D ** (-0.5)
    scores = torch.einsum('bhqd,bhkd->bhqk', q, k) * scale
    ctx_mask = torch.ones((B, 1, T, C), dtype=scores.dtype)
    tm = tree_mask[:, None, :, :].clone()
    full_mask = torch.concatenate([ctx_mask, tm], axis=-1)
    scores = scores + (1.0 - full_mask) * -1000000000.0
    p = _softmax(scores, axis=-1)
    return torch.einsum('bhqk,bhkd->bhqd', p, v)
```

```asm
; @launch grid=(256,1,1) block=(320,1,1) lds=8320
.amdgcn_target "amdgcn-amd-amdhsa--gfx950"
.text
.globl standalone__tree_speculative_verify_tree_attention_over_candidate_token_tree__decode_kernel
.p2align 8
.type standalone__tree_speculative_verify_tree_attention_over_candidate_token_tree__decode_kernel,@function
standalone__tree_speculative_verify_tree_attention_over_candidate_token_tree__decode_kernel:
s_load_dwordx2 s[12:13], s[0:1], 8
s_load_dwordx2 s[20:21], s[0:1], 0
s_load_dwordx2 s[16:17], s[0:1], 16
v_lshrrev_b32 v31, 6, v0
v_cmp_lt_u32 vcc, 3, v31
s_cmpk_ge_u32 s2, 256
s_cbranch_scc1 L_done
s_and_b32 s47, s2, 0x20
s_lshl_b32 s47, s47, 10
s_and_b32 s46, s2, 0x42
s_lshl_b32 s46, s46, 13
s_xor_b32 s47, s47, s46
s_and_b32 s46, s2, 0xc0
s_lshl_b32 s46, s46, 14
s_xor_b32 s47, s47, s46
s_and_b32 s46, s2, 0x4
s_lshl_b32 s46, s46, 16
s_xor_b32 s47, s47, s46
s_and_b32 s46, s2, 0x1e
s_lshl_b32 s46, s46, 21
s_xor_b32 s47, s47, s46
s_and_b32 s46, s2, 0x1
s_lshl_b32 s46, s46, 26
s_xor_b32 s47, s47, s46
s_cbranch_vccnz L_helper
v_and_b32 v28, 3, v0
v_bfe_u32 v29, v0, 4, 2
v_lshl_add_u32 v28, v29, 2, v28
v_lshlrev_b32 v28, 4, v28
v_bfe_u32 v30, v0, 2, 2
v_lshl_add_u32 v30, v31, 2, v30
v_lshl_add_u32 v1, v30, 9, v28
s_brev_b32 s14, 16
s_mov_b32 s15, 0x20000
s_waitcnt lgkmcnt(0)
buffer_load_dwordx4 v[56:59], v1, s[12:15], s47 offen offset:0 nt
buffer_load_dwordx4 v[60:63], v1, s[12:15], s47 offen offset:256 nt
s_xor_b32 s48, s47, 0x2000
buffer_load_dwordx4 v[64:67], v1, s[12:15], s48 offen offset:0 nt
buffer_load_dwordx4 v[68:71], v1, s[12:15], s48 offen offset:256 nt
s_xor_b32 s48, s47, 0x4000
buffer_load_dwordx4 v[72:75], v1, s[12:15], s48 offen offset:0 nt
v_bfe_u32 v30, v0, 3, 1
v_lshl_add_u32 v3, v30, 9, v28
s_lshr_b32 s7, s47, 21
s_lshl_b32 s7, s7, 10
s_mov_b32 s22, 0x10000
s_mov_b32 s23, 0x20000
buffer_load_dwordx4 v[32:35], v3, s[20:23], s7 offen offset:0
buffer_load_dwordx4 v[36:39], v3, s[20:23], s7 offen offset:256
s_brev_b32 s18, 16
s_mov_b32 s19, 0x20000
s_load_dwordx2 s[28:29], s[0:1], 64
s_mov_b32 s30, 0x208000
s_mov_b32 s31, 0x20000
s_and_b32 s50, s2, 7
s_lshl_b32 s50, s50, 12
s_add_u32 s50, s50, 0x200000
s_lshr_b32 s51, s2, 3
s_lshl_b32 s51, s51, 2
v_and_b32 v184, 63, v0
v_lshlrev_b32 v184, 1, v184
v_add_u32 v185, s51, v31
v_mov_b32 v186, 1
v_and_b32 v30, 15, v0
v_lshl_add_u32 v28, v31, 2, v29
v_lshlrev_b32 v28, 9, v28
v_lshl_add_u32 v2, v30, 4, v28
v_lshlrev_b32 v10, 4, v30
v_and_b32 v28, 1, v29
v_lshl_add_u32 v10, v28, 10, v10
v_lshrrev_b32 v28, 1, v29
v_lshl_add_u32 v10, v28, 9, v10
v_lshl_add_u32 v10, v31, 11, v10
v_bfe_u32 v28, v0, 3, 1
v_lshl_add_u32 v28, v31, 1, v28
v_lshlrev_b32 v11, 3, v28
v_and_b32 v30, 1, v0
v_lshlrev_b32 v30, 4, v30
v_mov_b32 v31, 0xffff
v_lshlrev_b32 v30, v30, v31
v_bfe_u32 v29, v0, 1, 2
v_cmp_eq_u32 vcc, 0, v29
v_mov_b32 v12, 0
v_mov_b32 v13, 0
v_cndmask_b32 v4, 0, v30, vcc
v_cmp_eq_u32 vcc, 1, v29
v_mov_b32 v14, 0
v_mov_b32 v15, 0
v_cndmask_b32 v5, 0, v30, vcc
v_cmp_eq_u32 vcc, 2, v29
v_mov_b32 v16, 0
v_mov_b32 v17, 0
v_cndmask_b32 v6, 0, v30, vcc
v_cmp_eq_u32 vcc, 3, v29
v_mov_b32 v18, 0
v_mov_b32 v19, 0
v_cndmask_b32 v7, 0, v30, vcc
v_mov_b32 v8, 0
v_mov_b32 v9, 0xff800000
s_mov_b32 s49, 0x3db8aa3b
s_waitcnt vmcnt(6)
buffer_load_dwordx4 v[76:79], v1, s[12:15], s48 offen offset:256 nt
s_waitcnt vmcnt(6)
s_xor_b32 s48, s47, 0x6000
buffer_load_dwordx4 v[80:83], v1, s[12:15], s48 offen offset:0 nt
s_waitcnt vmcnt(6)
buffer_load_dwordx4 v[84:87], v1, s[12:15], s48 offen offset:256 nt
s_waitcnt vmcnt(6)
s_xor_b32 s48, s47, 0x10000
buffer_load_dwordx4 v[88:91], v1, s[12:15], s48 offen offset:0 nt
s_waitcnt vmcnt(6)
buffer_load_dwordx4 v[92:95], v1, s[12:15], s48 offen offset:256 nt
s_waitcnt vmcnt(5)
s_waitcnt lgkmcnt(0)
v_mfma_f32_16x16x32_bf16 v[40:43], v[56:59], v[32:35], 0
s_nop 3
v_mfma_f32_16x16x32_bf16 v[40:43], v[60:63], v[36:39], v[40:43]
s_nop 3
v_mfma_f32_16x16x32_bf16 v[44:47], v[64:67], v[32:35], 0
s_nop 3
v_mfma_f32_16x16x32_bf16 v[44:47], v[68:71], v[36:39], v[44:47]
s_nop 3
v_mov_b32_dpp v120, v40 quad_perm:[0,0,0,0] row_mask:0xf bank_mask:0xf
v_mfma_f32_16x16x32_bf16 v[48:51], v[72:75], v[32:35], 0
s_nop 3
v_add_f32_dpp v120, v41, v120 quad_perm:[1,1,1,1] row_mask:0xf bank_mask:0xf
s_waitcnt vmcnt(4)
s_xor_b32 s48, s47, 0x12000
buffer_load_dwordx4 v[96:99], v1, s[12:15], s48 offen offset:0 nt
v_mfma_f32_16x16x32_bf16 v[48:51], v[76:79], v[36:39], v[48:51]
s_nop 3
v_add_f32_dpp v120, v42, v120 quad_perm:[2,2,2,2] row_mask:0xf bank_mask:0xf
v_mov_b32_dpp v121, v44 quad_perm:[0,0,0,0] row_mask:0xf bank_mask:0xf
s_waitcnt vmcnt(4)
buffer_load_dwordx4 v[100:103], v1, s[12:15], s48 offen offset:256 nt
v_mfma_f32_16x16x32_bf16 v[52:55], v[80:83], v[32:35], 0
v_add_f32_dpp v120, v43, v120 quad_perm:[3,3,3,3] row_mask:0xf bank_mask:0xf
v_add_f32_dpp v121, v45, v121 quad_perm:[1,1,1,1] row_mask:0xf bank_mask:0xf
s_waitcnt vmcnt(4)
s_xor_b32 s48, s47, 0x14000
buffer_load_dwordx4 v[104:107], v1, s[12:15], s48 offen offset:0 nt
v_mfma_f32_16x16x32_bf16 v[52:55], v[84:87], v[36:39], v[52:55]
v_add_f32_dpp v121, v46, v121 quad_perm:[2,2,2,2] row_mask:0xf bank_mask:0xf
v_mov_b32_dpp v122, v48 quad_perm:[0,0,0,0] row_mask:0xf bank_mask:0xf
s_waitcnt vmcnt(4)
buffer_load_dwordx4 v[108:111], v1, s[12:15], s48 offen offset:256 nt
v_mfma_f32_16x16x32_bf16 v[40:43], v[88:91], v[32:35], 0
v_add_f32_dpp v121, v47, v121 quad_perm:[3,3,3,3] row_mask:0xf bank_mask:0xf
v_add_f32_dpp v122, v49, v122 quad_perm:[1,1,1,1] row_mask:0xf bank_mask:0xf
s_waitcnt vmcnt(4)
s_xor_b32 s48, s47, 0x16000
buffer_load_dwordx4 v[112:115], v1, s[12:15], s48 offen offset:0 nt
v_mfma_f32_16x16x32_bf16 v[40:43], v[92:95], v[36:39], v[40:43]
v_max3_f32 v9, v120, v121, v9
v_add_f32_dpp v122, v50, v122 quad_perm:[2,2,2,2] row_mask:0xf bank_mask:0xf
v_mov_b32_dpp v123, v52 quad_perm:[0,0,0,0] row_mask:0xf bank_mask:0xf
s_waitcnt vmcnt(4)
buffer_load_dwordx4 v[116:119], v1, s[12:15], s48 offen offset:256 nt
v_mfma_f32_16x16x32_bf16 v[44:47], v[96:99], v[32:35], 0
v_add_f32_dpp v122, v51, v122 quad_perm:[3,3,3,3] row_mask:0xf bank_mask:0xf
v_add_f32_dpp v123, v53, v123 quad_perm:[1,1,1,1] row_mask:0xf bank_mask:0xf
s_waitcnt vmcnt(4)
s_xor_b32 s48, s47, 0x20000
buffer_load_dwordx4 v[56:59], v1, s[12:15], s48 offen offset:0 nt
v_mfma_f32_16x16x32_bf16 v[44:47], v[100:103], v[36:39], v[44:47]
v_add_f32_dpp v123, v54, v123 quad_perm:[2,2,2,2] row_mask:0xf bank_mask:0xf
v_mov_b32_dpp v124, v40 quad_perm:[0,0,0,0] row_mask:0xf bank_mask:0xf
s_waitcnt vmcnt(4)
buffer_load_dwordx4 v[60:63], v1, s[12:15], s48 offen offset:256 nt
v_mfma_f32_16x16x32_bf16 v[48:51], v[104:107], v[32:35], 0
v_add_f32_dpp v123, v55, v123 quad_perm:[3,3,3,3] row_mask:0xf bank_mask:0xf
v_add_f32_dpp v124, v41, v124 quad_perm:[1,1,1,1] row_mask:0xf bank_mask:0xf
s_waitcnt vmcnt(4)
s_xor_b32 s48, s47, 0x22000
buffer_load_dwordx4 v[64:67], v1, s[12:15], s48 offen offset:0 nt
v_mfma_f32_16x16x32_bf16 v[48:51], v[108:111], v[36:39], v[48:51]
v_max3_f32 v9, v122, v123, v9
v_add_f32_dpp v124, v42, v124 quad_perm:[2,2,2,2] row_mask:0xf bank_mask:0xf
v_mov_b32_dpp v125, v44 quad_perm:[0,0,0,0] row_mask:0xf bank_mask:0xf
s_waitcnt vmcnt(4)
buffer_load_dwordx4 v[68:71], v1, s[12:15], s48 offen offset:256 nt
v_mfma_f32_16x16x32_bf16 v[52:55], v[112:115], v[32:35], 0
v_add_f32_dpp v124, v43, v124 quad_perm:[3,3,3,3] row_mask:0xf bank_mask:0xf
v_add_f32_dpp v125, v45, v125 quad_perm:[1,1,1,1] row_mask:0xf bank_mask:0xf
s_waitcnt vmcnt(4)
s_xor_b32 s48, s47, 0x24000
buffer_load_dwordx4 v[72:75], v1, s[12:15], s48 offen offset:0 nt
v_mfma_f32_16x16x32_bf16 v[52:55], v[116:119], v[36:39], v[52:55]
v_add_f32_dpp v125, v46, v125 quad_perm:[2,2,2,2] row_mask:0xf bank_mask:0xf
v_mov_b32_dpp v126, v48 quad_perm:[0,0,0,0] row_mask:0xf bank_mask:0xf
s_waitcnt vmcnt(4)
buffer_load_dwordx4 v[76:79], v1, s[12:15], s48 offen offset:256 nt
v_mfma_f32_16x16x32_bf16 v[40:43], v[56:59], v[32:35], 0
v_add_f32_dpp v125, v47, v125 quad_perm:[3,3,3,3] row_mask:0xf bank_mask:0xf
v_add_f32_dpp v126, v49, v126 quad_perm:[1,1,1,1] row_mask:0xf bank_mask:0xf
s_waitcnt vmcnt(4)
s_xor_b32 s48, s47, 0x26000
buffer_load_dwordx4 v[80:83], v1, s[12:15], s48 offen offset:0 nt
v_mfma_f32_16x16x32_bf16 v[40:43], v[60:63], v[36:39], v[40:43]
v_max3_f32 v9, v124, v125, v9
v_add_f32_dpp v126, v50, v126 quad_perm:[2,2,2,2] row_mask:0xf bank_mask:0xf
v_mov_b32_dpp v127, v52 quad_perm:[0,0,0,0] row_mask:0xf bank_mask:0xf
s_waitcnt vmcnt(4)
buffer_load_dwordx4 v[84:87], v1, s[12:15], s48 offen offset:256 nt
v_mfma_f32_16x16x32_bf16 v[44:47], v[64:67], v[32:35], 0
v_add_f32_dpp v126, v51, v126 quad_perm:[3,3,3,3] row_mask:0xf bank_mask:0xf
v_add_f32_dpp v127, v53, v127 quad_perm:[1,1,1,1] row_mask:0xf bank_mask:0xf
s_waitcnt vmcnt(4)
s_xor_b32 s48, s47, 0x30000
buffer_load_dwordx4 v[88:91], v1, s[12:15], s48 offen offset:0 nt
v_mfma_f32_16x16x32_bf16 v[44:47], v[68:71], v[36:39], v[44:47]
v_add_f32_dpp v127, v54, v127 quad_perm:[2,2,2,2] row_mask:0xf bank_mask:0xf
v_mov_b32_dpp v128, v40 quad_perm:[0,0,0,0] row_mask:0xf bank_mask:0xf
s_waitcnt vmcnt(4)
buffer_load_dwordx4 v[92:95], v1, s[12:15], s48 offen offset:256 nt
v_mfma_f32_16x16x32_bf16 v[48:51], v[72:75], v[32:35], 0
v_add_f32_dpp v127, v55, v127 quad_perm:[3,3,3,3] row_mask:0xf bank_mask:0xf
v_add_f32_dpp v128, v41, v128 quad_perm:[1,1,1,1] row_mask:0xf bank_mask:0xf
s_waitcnt vmcnt(4)
s_xor_b32 s48, s47, 0x32000
buffer_load_dwordx4 v[96:99], v1, s[12:15], s48 offen offset:0 nt
v_mfma_f32_16x16x32_bf16 v[48:51], v[76:79], v[36:39], v[48:51]
v_max3_f32 v9, v126, v127, v9
v_add_f32_dpp v128, v42, v128 quad_perm:[2,2,2,2] row_mask:0xf bank_mask:0xf
v_mov_b32_dpp v129, v44 quad_perm:[0,0,0,0] row_mask:0xf bank_mask:0xf
s_waitcnt vmcnt(4)
buffer_load_dwordx4 v[100:103], v1, s[12:15], s48 offen offset:256 nt
v_mfma_f32_16x16x32_bf16 v[52:55], v[80:83], v[32:35], 0
v_add_f32_dpp v128, v43, v128 quad_perm:[3,3,3,3] row_mask:0xf bank_mask:0xf
v_add_f32_dpp v129, v45, v129 quad_perm:[1,1,1,1] row_mask:0xf bank_mask:0xf
s_waitcnt vmcnt(4)
s_xor_b32 s48, s47, 0x34000
buffer_load_dwordx4 v[104:107], v1, s[12:15], s48 offen offset:0 nt
v_mfma_f32_16x16x32_bf16 v[52:55], v[84:87], v[36:39], v[52:55]
v_add_f32_dpp v129, v46, v129 quad_perm:[2,2,2,2] row_mask:0xf bank_mask:0xf
v_mov_b32_dpp v130, v48 quad_perm:[0,0,0,0] row_mask:0xf bank_mask:0xf
s_waitcnt vmcnt(4)
buffer_load_dwordx4 v[108:111], v1, s[12:15], s48 offen offset:256 nt
v_mfma_f32_16x16x32_bf16 v[40:43], v[88:91], v[32:35], 0
v_add_f32_dpp v129, v47, v129 quad_perm:[3,3,3,3] row_mask:0xf bank_mask:0xf
v_add_f32_dpp v130, v49, v130 quad_perm:[1,1,1,1] row_mask:0xf bank_mask:0xf
s_waitcnt vmcnt(4)
s_xor_b32 s48, s47, 0x36000
buffer_load_dwordx4 v[112:115], v1, s[12:15], s48 offen offset:0 nt
v_mfma_f32_16x16x32_bf16 v[40:43], v[92:95], v[36:39], v[40:43]
v_max3_f32 v9, v128, v129, v9
v_add_f32_dpp v130, v50, v130 quad_perm:[2,2,2,2] row_mask:0xf bank_mask:0xf
v_mov_b32_dpp v131, v52 quad_perm:[0,0,0,0] row_mask:0xf bank_mask:0xf
s_waitcnt vmcnt(4)
buffer_load_dwordx4 v[116:119], v1, s[12:15], s48 offen offset:256 nt
v_mfma_f32_16x16x32_bf16 v[44:47], v[96:99], v[32:35], 0
v_add_f32_dpp v130, v51, v130 quad_perm:[3,3,3,3] row_mask:0xf bank_mask:0xf
v_add_f32_dpp v131, v53, v131 quad_perm:[1,1,1,1] row_mask:0xf bank_mask:0xf
s_waitcnt vmcnt(4)
s_xor_b32 s48, s47, 0x40000
buffer_load_dwordx4 v[56:59], v1, s[12:15], s48 offen offset:0 nt
v_mfma_f32_16x16x32_bf16 v[44:47], v[100:103], v[36:39], v[44:47]
v_add_f32_dpp v131, v54, v131 quad_perm:[2,2,2,2] row_mask:0xf bank_mask:0xf
v_mov_b32_dpp v132, v40 quad_perm:[0,0,0,0] row_mask:0xf bank_mask:0xf
s_waitcnt vmcnt(4)
buffer_load_dwordx4 v[60:63], v1, s[12:15], s48 offen offset:256 nt
v_mfma_f32_16x16x32_bf16 v[48:51], v[104:107], v[32:35], 0
v_add_f32_dpp v131, v55, v131 quad_perm:[3,3,3,3] row_mask:0xf bank_mask:0xf
v_add_f32_dpp v132, v41, v132 quad_perm:[1,1,1,1] row_mask:0xf bank_mask:0xf
s_waitcnt vmcnt(4)
s_xor_b32 s48, s47, 0x42000
buffer_load_dwordx4 v[64:67], v1, s[12:15], s48 offen offset:0 nt
v_mfma_f32_16x16x32_bf16 v[48:51], v[108:111], v[36:39], v[48:51]
v_max3_f32 v9, v130, v131, v9
v_add_f32_dpp v132, v42, v132 quad_perm:[2,2,2,2] row_mask:0xf bank_mask:0xf
v_mov_b32_dpp v133, v44 quad_perm:[0,0,0,0] row_mask:0xf bank_mask:0xf
s_waitcnt vmcnt(4)
buffer_load_dwordx4 v[68:71], v1, s[12:15], s48 offen offset:256 nt
v_mfma_f32_16x16x32_bf16 v[52:55], v[112:115], v[32:35], 0
v_add_f32_dpp v132, v43, v132 quad_perm:[3,3,3,3] row_mask:0xf bank_mask:0xf
v_add_f32_dpp v133, v45, v133 quad_perm:[1,1,1,1] row_mask:0xf bank_mask:0xf
s_waitcnt vmcnt(4)
s_xor_b32 s48, s47, 0x44000
buffer_load_dwordx4 v[72:75], v1, s[12:15], s48 offen offset:0 nt
v_mfma_f32_16x16x32_bf16 v[52:55], v[116:119], v[36:39], v[52:55]
v_add_f32_dpp v133, v46, v133 quad_perm:[2,2,2,2] row_mask:0xf bank_mask:0xf
v_mov_b32_dpp v134, v48 quad_perm:[0,0,0,0] row_mask:0xf bank_mask:0xf
s_waitcnt vmcnt(4)
buffer_load_dwordx4 v[76:79], v1, s[12:15], s48 offen offset:256 nt
v_mfma_f32_16x16x32_bf16 v[40:43], v[56:59], v[32:35], 0
v_add_f32_dpp v133, v47, v133 quad_perm:[3,3,3,3] row_mask:0xf bank_mask:0xf
v_add_f32_dpp v134, v49, v134 quad_perm:[1,1,1,1] row_mask:0xf bank_mask:0xf
s_waitcnt vmcnt(4)
s_xor_b32 s48, s47, 0x46000
buffer_load_dwordx4 v[80:83], v1, s[12:15], s48 offen offset:0 nt
v_mfma_f32_16x16x32_bf16 v[40:43], v[60:63], v[36:39], v[40:43]
v_max3_f32 v9, v132, v133, v9
v_add_f32_dpp v134, v50, v134 quad_perm:[2,2,2,2] row_mask:0xf bank_mask:0xf
v_mov_b32_dpp v135, v52 quad_perm:[0,0,0,0] row_mask:0xf bank_mask:0xf
s_waitcnt vmcnt(4)
buffer_load_dwordx4 v[84:87], v1, s[12:15], s48 offen offset:256 nt
v_mfma_f32_16x16x32_bf16 v[44:47], v[64:67], v[32:35], 0
v_add_f32_dpp v134, v51, v134 quad_perm:[3,3,3,3] row_mask:0xf bank_mask:0xf
v_add_f32_dpp v135, v53, v135 quad_perm:[1,1,1,1] row_mask:0xf bank_mask:0xf
s_waitcnt vmcnt(4)
s_xor_b32 s48, s47, 0x50000
buffer_load_dwordx4 v[88:91], v1, s[12:15], s48 offen offset:0 nt
v_mfma_f32_16x16x32_bf16 v[44:47], v[68:71], v[36:39], v[44:47]
v_add_f32_dpp v135, v54, v135 quad_perm:[2,2,2,2] row_mask:0xf bank_mask:0xf
v_mov_b32_dpp v136, v40 quad_perm:[0,0,0,0] row_mask:0xf bank_mask:0xf
s_waitcnt vmcnt(4)
buffer_load_dwordx4 v[92:95], v1, s[12:15], s48 offen offset:256 nt
v_mfma_f32_16x16x32_bf16 v[48:51], v[72:75], v[32:35], 0
v_add_f32_dpp v135, v55, v135 quad_perm:[3,3,3,3] row_mask:0xf bank_mask:0xf
v_add_f32_dpp v136, v41, v136 quad_perm:[1,1,1,1] row_mask:0xf bank_mask:0xf
s_waitcnt vmcnt(4)
s_xor_b32 s48, s47, 0x52000
buffer_load_dwordx4 v[96:99], v1, s[12:15], s48 offen offset:0 nt
v_mfma_f32_16x16x32_bf16 v[48:51], v[76:79], v[36:39], v[48:51]
v_max3_f32 v9, v134, v135, v9
v_add_f32_dpp v136, v42, v136 quad_perm:[2,2,2,2] row_mask:0xf bank_mask:0xf
v_mov_b32_dpp v137, v44 quad_perm:[0,0,0,0] row_mask:0xf bank_mask:0xf
s_waitcnt vmcnt(4)
buffer_load_dwordx4 v[100:103], v1, s[12:15], s48 offen offset:256 nt
v_mfma_f32_16x16x32_bf16 v[52:55], v[80:83], v[32:35], 0
v_add_f32_dpp v136, v43, v136 quad_perm:[3,3,3,3] row_mask:0xf bank_mask:0xf
v_add_f32_dpp v137, v45, v137 quad_perm:[1,1,1,1] row_mask:0xf bank_mask:0xf
s_waitcnt vmcnt(4)
s_xor_b32 s48, s47, 0x54000
buffer_load_dwordx4 v[104:107], v1, s[12:15], s48 offen offset:0 nt
v_mfma_f32_16x16x32_bf16 v[52:55], v[84:87], v[36:39], v[52:55]
v_add_f32_dpp v137, v46, v137 quad_perm:[2,2,2,2] row_mask:0xf bank_mask:0xf
v_mov_b32_dpp v138, v48 quad_perm:[0,0,0,0] row_mask:0xf bank_mask:0xf
s_waitcnt vmcnt(4)
buffer_load_dwordx4 v[108:111], v1, s[12:15], s48 offen offset:256 nt
v_mfma_f32_16x16x32_bf16 v[40:43], v[88:91], v[32:35], 0
v_add_f32_dpp v137, v47, v137 quad_perm:[3,3,3,3] row_mask:0xf bank_mask:0xf
v_add_f32_dpp v138, v49, v138 quad_perm:[1,1,1,1] row_mask:0xf bank_mask:0xf
s_waitcnt vmcnt(4)
s_xor_b32 s48, s47, 0x56000
buffer_load_dwordx4 v[112:115], v1, s[12:15], s48 offen offset:0 nt
v_mfma_f32_16x16x32_bf16 v[40:43], v[92:95], v[36:39], v[40:43]
v_max3_f32 v9, v136, v137, v9
v_add_f32_dpp v138, v50, v138 quad_perm:[2,2,2,2] row_mask:0xf bank_mask:0xf
v_mov_b32_dpp v139, v52 quad_perm:[0,0,0,0] row_mask:0xf bank_mask:0xf
s_waitcnt vmcnt(4)
buffer_load_dwordx4 v[116:119], v1, s[12:15], s48 offen offset:256 nt
v_mfma_f32_16x16x32_bf16 v[44:47], v[96:99], v[32:35], 0
v_add_f32_dpp v138, v51, v138 quad_perm:[3,3,3,3] row_mask:0xf bank_mask:0xf
v_add_f32_dpp v139, v53, v139 quad_perm:[1,1,1,1] row_mask:0xf bank_mask:0xf
s_waitcnt vmcnt(4)
s_xor_b32 s48, s47, 0x60000
buffer_load_dwordx4 v[56:59], v1, s[12:15], s48 offen offset:0 nt
v_mfma_f32_16x16x32_bf16 v[44:47], v[100:103], v[36:39], v[44:47]
v_add_f32_dpp v139, v54, v139 quad_perm:[2,2,2,2] row_mask:0xf bank_mask:0xf
v_mov_b32_dpp v140, v40 quad_perm:[0,0,0,0] row_mask:0xf bank_mask:0xf
s_waitcnt vmcnt(4)
buffer_load_dwordx4 v[60:63], v1, s[12:15], s48 offen offset:256 nt
v_mfma_f32_16x16x32_bf16 v[48:51], v[104:107], v[32:35], 0
v_add_f32_dpp v139, v55, v139 quad_perm:[3,3,3,3] row_mask:0xf bank_mask:0xf
v_add_f32_dpp v140, v41, v140 quad_perm:[1,1,1,1] row_mask:0xf bank_mask:0xf
s_waitcnt vmcnt(4)
s_xor_b32 s48, s47, 0x62000
buffer_load_dwordx4 v[64:67], v1, s[12:15], s48 offen offset:0 nt
v_mfma_f32_16x16x32_bf16 v[48:51], v[108:111], v[36:39], v[48:51]
v_max3_f32 v9, v138, v139, v9
v_add_f32_dpp v140, v42, v140 quad_perm:[2,2,2,2] row_mask:0xf bank_mask:0xf
v_mov_b32_dpp v141, v44 quad_perm:[0,0,0,0] row_mask:0xf bank_mask:0xf
s_waitcnt vmcnt(4)
buffer_load_dwordx4 v[68:71], v1, s[12:15], s48 offen offset:256 nt
v_mfma_f32_16x16x32_bf16 v[52:55], v[112:115], v[32:35], 0
v_add_f32_dpp v140, v43, v140 quad_perm:[3,3,3,3] row_mask:0xf bank_mask:0xf
v_add_f32_dpp v141, v45, v141 quad_perm:[1,1,1,1] row_mask:0xf bank_mask:0xf
s_waitcnt vmcnt(4)
s_xor_b32 s48, s47, 0x64000
buffer_load_dwordx4 v[72:75], v1, s[12:15], s48 offen offset:0 nt
v_mfma_f32_16x16x32_bf16 v[52:55], v[116:119], v[36:39], v[52:55]
v_add_f32_dpp v141, v46, v141 quad_perm:[2,2,2,2] row_mask:0xf bank_mask:0xf
v_mov_b32_dpp v142, v48 quad_perm:[0,0,0,0] row_mask:0xf bank_mask:0xf
s_waitcnt vmcnt(4)
buffer_load_dwordx4 v[76:79], v1, s[12:15], s48 offen offset:256 nt
v_mfma_f32_16x16x32_bf16 v[40:43], v[56:59], v[32:35], 0
v_add_f32_dpp v141, v47, v141 quad_perm:[3,3,3,3] row_mask:0xf bank_mask:0xf
v_add_f32_dpp v142, v49, v142 quad_perm:[1,1,1,1] row_mask:0xf bank_mask:0xf
s_waitcnt vmcnt(4)
s_xor_b32 s48, s47, 0x66000
buffer_load_dwordx4 v[80:83], v1, s[12:15], s48 offen offset:0 nt
v_mfma_f32_16x16x32_bf16 v[40:43], v[60:63], v[36:39], v[40:43]
v_max3_f32 v9, v140, v141, v9
v_add_f32_dpp v142, v50, v142 quad_perm:[2,2,2,2] row_mask:0xf bank_mask:0xf
v_mov_b32_dpp v143, v52 quad_perm:[0,0,0,0] row_mask:0xf bank_mask:0xf
s_waitcnt vmcnt(4)
buffer_load_dwordx4 v[84:87], v1, s[12:15], s48 offen offset:256 nt
v_mfma_f32_16x16x32_bf16 v[44:47], v[64:67], v[32:35], 0
v_add_f32_dpp v142, v51, v142 quad_perm:[3,3,3,3] row_mask:0xf bank_mask:0xf
v_add_f32_dpp v143, v53, v143 quad_perm:[1,1,1,1] row_mask:0xf bank_mask:0xf
s_waitcnt vmcnt(4)
s_xor_b32 s48, s47, 0x70000
buffer_load_dwordx4 v[88:91], v1, s[12:15], s48 offen offset:0 nt
v_mfma_f32_16x16x32_bf16 v[44:47], v[68:71], v[36:39], v[44:47]
v_add_f32_dpp v143, v54, v143 quad_perm:[2,2,2,2] row_mask:0xf bank_mask:0xf
v_mov_b32_dpp v144, v40 quad_perm:[0,0,0,0] row_mask:0xf bank_mask:0xf
s_waitcnt vmcnt(4)
buffer_load_dwordx4 v[92:95], v1, s[12:15], s48 offen offset:256 nt
v_mfma_f32_16x16x32_bf16 v[48:51], v[72:75], v[32:35], 0
v_add_f32_dpp v143, v55, v143 quad_perm:[3,3,3,3] row_mask:0xf bank_mask:0xf
v_add_f32_dpp v144, v41, v144 quad_perm:[1,1,1,1] row_mask:0xf bank_mask:0xf
s_waitcnt vmcnt(4)
s_xor_b32 s48, s47, 0x72000
buffer_load_dwordx4 v[96:99], v1, s[12:15], s48 offen offset:0 nt
v_mfma_f32_16x16x32_bf16 v[48:51], v[76:79], v[36:39], v[48:51]
v_max3_f32 v9, v142, v143, v9
v_add_f32_dpp v144, v42, v144 quad_perm:[2,2,2,2] row_mask:0xf bank_mask:0xf
v_mov_b32_dpp v145, v44 quad_perm:[0,0,0,0] row_mask:0xf bank_mask:0xf
s_waitcnt vmcnt(4)
buffer_load_dwordx4 v[100:103], v1, s[12:15], s48 offen offset:256 nt
v_mfma_f32_16x16x32_bf16 v[52:55], v[80:83], v[32:35], 0
v_add_f32_dpp v144, v43, v144 quad_perm:[3,3,3,3] row_mask:0xf bank_mask:0xf
v_add_f32_dpp v145, v45, v145 quad_perm:[1,1,1,1] row_mask:0xf bank_mask:0xf
s_waitcnt vmcnt(4)
s_xor_b32 s48, s47, 0x74000
buffer_load_dwordx4 v[104:107], v1, s[12:15], s48 offen offset:0 nt
v_mfma_f32_16x16x32_bf16 v[52:55], v[84:87], v[36:39], v[52:55]
v_add_f32_dpp v145, v46, v145 quad_perm:[2,2,2,2] row_mask:0xf bank_mask:0xf
v_mov_b32_dpp v146, v48 quad_perm:[0,0,0,0] row_mask:0xf bank_mask:0xf
s_waitcnt vmcnt(4)
buffer_load_dwordx4 v[108:111], v1, s[12:15], s48 offen offset:256 nt
v_mfma_f32_16x16x32_bf16 v[40:43], v[88:91], v[32:35], 0
v_add_f32_dpp v145, v47, v145 quad_perm:[3,3,3,3] row_mask:0xf bank_mask:0xf
v_add_f32_dpp v146, v49, v146 quad_perm:[1,1,1,1] row_mask:0xf bank_mask:0xf
s_waitcnt vmcnt(4)
s_xor_b32 s48, s47, 0x76000
buffer_load_dwordx4 v[112:115], v1, s[12:15], s48 offen offset:0 nt
v_mfma_f32_16x16x32_bf16 v[40:43], v[92:95], v[36:39], v[40:43]
v_max3_f32 v9, v144, v145, v9
v_add_f32_dpp v146, v50, v146 quad_perm:[2,2,2,2] row_mask:0xf bank_mask:0xf
v_mov_b32_dpp v147, v52 quad_perm:[0,0,0,0] row_mask:0xf bank_mask:0xf
s_waitcnt vmcnt(4)
buffer_load_dwordx4 v[116:119], v1, s[12:15], s48 offen offset:256 nt
v_mfma_f32_16x16x32_bf16 v[44:47], v[96:99], v[32:35], 0
v_add_f32_dpp v146, v51, v146 quad_perm:[3,3,3,3] row_mask:0xf bank_mask:0xf
v_add_f32_dpp v147, v53, v147 quad_perm:[1,1,1,1] row_mask:0xf bank_mask:0xf
s_waitcnt vmcnt(4)
s_xor_b32 s48, s47, 0x100000
buffer_load_dwordx4 v[56:59], v1, s[12:15], s48 offen offset:0 nt
v_mfma_f32_16x16x32_bf16 v[44:47], v[100:103], v[36:39], v[44:47]
v_add_f32_dpp v147, v54, v147 quad_perm:[2,2,2,2] row_mask:0xf bank_mask:0xf
v_mov_b32_dpp v148, v40 quad_perm:[0,0,0,0] row_mask:0xf bank_mask:0xf
s_waitcnt vmcnt(4)
buffer_load_dwordx4 v[60:63], v1, s[12:15], s48 offen offset:256 nt
v_mfma_f32_16x16x32_bf16 v[48:51], v[104:107], v[32:35], 0
v_add_f32_dpp v147, v55, v147 quad_perm:[3,3,3,3] row_mask:0xf bank_mask:0xf
v_add_f32_dpp v148, v41, v148 quad_perm:[1,1,1,1] row_mask:0xf bank_mask:0xf
s_waitcnt vmcnt(4)
s_xor_b32 s48, s47, 0x102000
buffer_load_dwordx4 v[64:67], v1, s[12:15], s48 offen offset:0 nt
v_mfma_f32_16x16x32_bf16 v[48:51], v[108:111], v[36:39], v[48:51]
v_max3_f32 v9, v146, v147, v9
v_add_f32_dpp v148, v42, v148 quad_perm:[2,2,2,2] row_mask:0xf bank_mask:0xf
v_mov_b32_dpp v149, v44 quad_perm:[0,0,0,0] row_mask:0xf bank_mask:0xf
s_waitcnt vmcnt(4)
buffer_load_dwordx4 v[68:71], v1, s[12:15], s48 offen offset:256 nt
v_mfma_f32_16x16x32_bf16 v[52:55], v[112:115], v[32:35], 0
v_add_f32_dpp v148, v43, v148 quad_perm:[3,3,3,3] row_mask:0xf bank_mask:0xf
v_add_f32_dpp v149, v45, v149 quad_perm:[1,1,1,1] row_mask:0xf bank_mask:0xf
s_waitcnt vmcnt(4)
s_xor_b32 s48, s47, 0x104000
buffer_load_dwordx4 v[72:75], v1, s[12:15], s48 offen offset:0 nt
v_mfma_f32_16x16x32_bf16 v[52:55], v[116:119], v[36:39], v[52:55]
v_add_f32_dpp v149, v46, v149 quad_perm:[2,2,2,2] row_mask:0xf bank_mask:0xf
v_mov_b32_dpp v150, v48 quad_perm:[0,0,0,0] row_mask:0xf bank_mask:0xf
s_waitcnt vmcnt(4)
buffer_load_dwordx4 v[76:79], v1, s[12:15], s48 offen offset:256 nt
v_mfma_f32_16x16x32_bf16 v[40:43], v[56:59], v[32:35], 0
v_add_f32_dpp v149, v47, v149 quad_perm:[3,3,3,3] row_mask:0xf bank_mask:0xf
v_add_f32_dpp v150, v49, v150 quad_perm:[1,1,1,1] row_mask:0xf bank_mask:0xf
s_waitcnt vmcnt(4)
s_xor_b32 s48, s47, 0x106000
buffer_load_dwordx4 v[80:83], v1, s[12:15], s48 offen offset:0 nt
v_mfma_f32_16x16x32_bf16 v[40:43], v[60:63], v[36:39], v[40:43]
v_max3_f32 v9, v148, v149, v9
v_add_f32_dpp v150, v50, v150 quad_perm:[2,2,2,2] row_mask:0xf bank_mask:0xf
v_mov_b32_dpp v151, v52 quad_perm:[0,0,0,0] row_mask:0xf bank_mask:0xf
s_waitcnt vmcnt(4)
buffer_load_dwordx4 v[84:87], v1, s[12:15], s48 offen offset:256 nt
v_mfma_f32_16x16x32_bf16 v[44:47], v[64:67], v[32:35], 0
v_add_f32_dpp v150, v51, v150 quad_perm:[3,3,3,3] row_mask:0xf bank_mask:0xf
v_add_f32_dpp v151, v53, v151 quad_perm:[1,1,1,1] row_mask:0xf bank_mask:0xf
s_waitcnt vmcnt(4)
s_xor_b32 s48, s47, 0x110000
buffer_load_dwordx4 v[88:91], v1, s[12:15], s48 offen offset:0 nt
v_mfma_f32_16x16x32_bf16 v[44:47], v[68:71], v[36:39], v[44:47]
v_add_f32_dpp v151, v54, v151 quad_perm:[2,2,2,2] row_mask:0xf bank_mask:0xf
v_mov_b32_dpp v152, v40 quad_perm:[0,0,0,0] row_mask:0xf bank_mask:0xf
s_waitcnt vmcnt(4)
buffer_load_dwordx4 v[92:95], v1, s[12:15], s48 offen offset:256 nt
v_mfma_f32_16x16x32_bf16 v[48:51], v[72:75], v[32:35], 0
v_add_f32_dpp v151, v55, v151 quad_perm:[3,3,3,3] row_mask:0xf bank_mask:0xf
v_add_f32_dpp v152, v41, v152 quad_perm:[1,1,1,1] row_mask:0xf bank_mask:0xf
s_waitcnt vmcnt(4)
s_xor_b32 s48, s47, 0x112000
buffer_load_dwordx4 v[96:99], v1, s[12:15], s48 offen offset:0 nt
v_mfma_f32_16x16x32_bf16 v[48:51], v[76:79], v[36:39], v[48:51]
v_max3_f32 v9, v150, v151, v9
v_add_f32_dpp v152, v42, v152 quad_perm:[2,2,2,2] row_mask:0xf bank_mask:0xf
v_mov_b32_dpp v153, v44 quad_perm:[0,0,0,0] row_mask:0xf bank_mask:0xf
s_waitcnt vmcnt(4)
buffer_load_dwordx4 v[100:103], v1, s[12:15], s48 offen offset:256 nt
v_mfma_f32_16x16x32_bf16 v[52:55], v[80:83], v[32:35], 0
v_add_f32_dpp v152, v43, v152 quad_perm:[3,3,3,3] row_mask:0xf bank_mask:0xf
v_add_f32_dpp v153, v45, v153 quad_perm:[1,1,1,1] row_mask:0xf bank_mask:0xf
s_waitcnt vmcnt(4)
s_xor_b32 s48, s47, 0x114000
buffer_load_dwordx4 v[104:107], v1, s[12:15], s48 offen offset:0 nt
v_mfma_f32_16x16x32_bf16 v[52:55], v[84:87], v[36:39], v[52:55]
v_add_f32_dpp v153, v46, v153 quad_perm:[2,2,2,2] row_mask:0xf bank_mask:0xf
v_mov_b32_dpp v154, v48 quad_perm:[0,0,0,0] row_mask:0xf bank_mask:0xf
s_waitcnt vmcnt(4)
buffer_load_dwordx4 v[108:111], v1, s[12:15], s48 offen offset:256 nt
v_mfma_f32_16x16x32_bf16 v[40:43], v[88:91], v[32:35], 0
v_add_f32_dpp v153, v47, v153 quad_perm:[3,3,3,3] row_mask:0xf bank_mask:0xf
v_add_f32_dpp v154, v49, v154 quad_perm:[1,1,1,1] row_mask:0xf bank_mask:0xf
s_waitcnt vmcnt(4)
s_xor_b32 s48, s47, 0x116000
buffer_load_dwordx4 v[112:115], v1, s[12:15], s48 offen offset:0 nt
v_mfma_f32_16x16x32_bf16 v[40:43], v[92:95], v[36:39], v[40:43]
v_max3_f32 v9, v152, v153, v9
v_add_f32_dpp v154, v50, v154 quad_perm:[2,2,2,2] row_mask:0xf bank_mask:0xf
v_mov_b32_dpp v155, v52 quad_perm:[0,0,0,0] row_mask:0xf bank_mask:0xf
s_waitcnt vmcnt(4)
buffer_load_dwordx4 v[116:119], v1, s[12:15], s48 offen offset:256 nt
v_mfma_f32_16x16x32_bf16 v[44:47], v[96:99], v[32:35], 0
v_add_f32_dpp v154, v51, v154 quad_perm:[3,3,3,3] row_mask:0xf bank_mask:0xf
v_add_f32_dpp v155, v53, v155 quad_perm:[1,1,1,1] row_mask:0xf bank_mask:0xf
s_waitcnt vmcnt(4)
s_xor_b32 s48, s47, 0x120000
buffer_load_dwordx4 v[56:59], v1, s[12:15], s48 offen offset:0 nt
buffer_load_ushort v30, v184, s[28:31], s50 offen offset:0 nt
buffer_store_byte v186, v185, s[28:31], s50 offen offset:0
s_waitcnt vmcnt(6)
buffer_load_dwordx4 v[60:63], v1, s[12:15], s48 offen offset:256 nt
s_waitcnt vmcnt(6)
s_xor_b32 s48, s47, 0x122000
buffer_load_dwordx4 v[64:67], v1, s[12:15], s48 offen offset:0 nt
v_mfma_f32_16x16x32_bf16 v[44:47], v[100:103], v[36:39], v[44:47]
v_add_f32_dpp v155, v54, v155 quad_perm:[2,2,2,2] row_mask:0xf bank_mask:0xf
v_mov_b32_dpp v156, v40 quad_perm:[0,0,0,0] row_mask:0xf bank_mask:0xf
s_waitcnt vmcnt(6)
buffer_load_dwordx4 v[68:71], v1, s[12:15], s48 offen offset:256 nt
v_mfma_f32_16x16x32_bf16 v[48:51], v[104:107], v[32:35], 0
v_add_f32_dpp v155, v55, v155 quad_perm:[3,3,3,3] row_mask:0xf bank_mask:0xf
v_add_f32_dpp v156, v41, v156 quad_perm:[1,1,1,1] row_mask:0xf bank_mask:0xf
s_waitcnt vmcnt(6)
s_xor_b32 s48, s47, 0x124000
buffer_load_dwordx4 v[72:75], v1, s[12:15], s48 offen offset:0 nt
v_mfma_f32_16x16x32_bf16 v[48:51], v[108:111], v[36:39], v[48:51]
v_max3_f32 v9, v154, v155, v9
v_add_f32_dpp v156, v42, v156 quad_perm:[2,2,2,2] row_mask:0xf bank_mask:0xf
v_mov_b32_dpp v157, v44 quad_perm:[0,0,0,0] row_mask:0xf bank_mask:0xf
s_waitcnt vmcnt(6)
buffer_load_dwordx4 v[76:79], v1, s[12:15], s48 offen offset:256 nt
v_mfma_f32_16x16x32_bf16 v[52:55], v[112:115], v[32:35], 0
v_add_f32_dpp v156, v43, v156 quad_perm:[3,3,3,3] row_mask:0xf bank_mask:0xf
v_add_f32_dpp v157, v45, v157 quad_perm:[1,1,1,1] row_mask:0xf bank_mask:0xf
s_waitcnt vmcnt(4)
s_xor_b32 s48, s47, 0x126000
buffer_load_dwordx4 v[80:83], v1, s[12:15], s48 offen offset:0 nt
v_cmp_lt_u32 vcc, 0xff, v30
v_and_b32 v30, 0xff, v30
s_bcnt1_i32_b64 s54, vcc
v_cmp_ne_u32 vcc, 0, v30
s_nop 1
s_bcnt1_i32_b64 s55, vcc
s_add_u32 s54, s54, s55
s_sub_i32 s55, s54, 112
s_max_i32 s55, s55, 0
s_mul_i32 s55, s55, 10
s_sub_i32 s54, s54, 64
s_max_i32 s54, s54, 0
s_mul_i32 s54, s54, 4
s_add_u32 s54, s54, s55
s_lshr_b32 s54, s54, 4
v_mfma_f32_16x16x32_bf16 v[52:55], v[116:119], v[36:39], v[52:55]
v_add_f32_dpp v157, v46, v157 quad_perm:[2,2,2,2] row_mask:0xf bank_mask:0xf
v_mov_b32_dpp v158, v48 quad_perm:[0,0,0,0] row_mask:0xf bank_mask:0xf
s_cmp_gt_u32 s54, 0
s_cbranch_scc1 L_b87
s_waitcnt vmcnt(4)
L_b87:
buffer_load_dwordx4 v[84:87], v1, s[12:15], s48 offen offset:256 nt
v_mfma_f32_16x16x32_bf16 v[40:43], v[56:59], v[32:35], 0
v_add_f32_dpp v157, v47, v157 quad_perm:[3,3,3,3] row_mask:0xf bank_mask:0xf
v_add_f32_dpp v158, v49, v158 quad_perm:[1,1,1,1] row_mask:0xf bank_mask:0xf
s_cmp_gt_u32 s54, 1
s_cbranch_scc1 L_b88
s_waitcnt vmcnt(4)
L_b88:
s_xor_b32 s48, s47, 0x130000
buffer_load_dwordx4 v[88:91], v1, s[12:15], s48 offen offset:0 nt
v_mfma_f32_16x16x32_bf16 v[40:43], v[60:63], v[36:39], v[40:43]
v_max3_f32 v9, v156, v157, v9
v_add_f32_dpp v158, v50, v158 quad_perm:[2,2,2,2] row_mask:0xf bank_mask:0xf
v_mov_b32_dpp v159, v52 quad_perm:[0,0,0,0] row_mask:0xf bank_mask:0xf
s_cmp_gt_u32 s54, 2
s_cbranch_scc1 L_b89
s_waitcnt vmcnt(4)
L_b89:
s_waitcnt vmcnt(6)
buffer_load_dwordx4 v[92:95], v1, s[12:15], s48 offen offset:256 nt
v_mfma_f32_16x16x32_bf16 v[44:47], v[64:67], v[32:35], 0
v_add_f32_dpp v158, v51, v158 quad_perm:[3,3,3,3] row_mask:0xf bank_mask:0xf
v_add_f32_dpp v159, v53, v159 quad_perm:[1,1,1,1] row_mask:0xf bank_mask:0xf
s_cmp_gt_u32 s54, 3
s_cbranch_scc1 L_b90
s_waitcnt vmcnt(4)
L_b90:
s_waitcnt vmcnt(6)
s_xor_b32 s48, s47, 0x132000
buffer_load_dwordx4 v[96:99], v1, s[12:15], s48 offen offset:0 nt
v_mfma_f32_16x16x32_bf16 v[44:47], v[68:71], v[36:39], v[44:47]
v_add_f32_dpp v159, v54, v159 quad_perm:[2,2,2,2] row_mask:0xf bank_mask:0xf
v_mov_b32_dpp v160, v40 quad_perm:[0,0,0,0] row_mask:0xf bank_mask:0xf
s_cmp_gt_u32 s54, 4
s_cbranch_scc1 L_b91
s_waitcnt vmcnt(4)
L_b91:
s_waitcnt vmcnt(6)
buffer_load_dwordx4 v[100:103], v1, s[12:15], s48 offen offset:256 nt
v_mfma_f32_16x16x32_bf16 v[48:51], v[72:75], v[32:35], 0
v_add_f32_dpp v159, v55, v159 quad_perm:[3,3,3,3] row_mask:0xf bank_mask:0xf
v_add_f32_dpp v160, v41, v160 quad_perm:[1,1,1,1] row_mask:0xf bank_mask:0xf
s_cmp_gt_u32 s54, 5
s_cbranch_scc1 L_b92
s_waitcnt vmcnt(4)
L_b92:
s_waitcnt vmcnt(6)
s_xor_b32 s48, s47, 0x134000
buffer_load_dwordx4 v[104:107], v1, s[12:15], s48 offen offset:0 nt
v_mfma_f32_16x16x32_bf16 v[48:51], v[76:79], v[36:39], v[48:51]
v_max3_f32 v9, v158, v159, v9
v_add_f32_dpp v160, v42, v160 quad_perm:[2,2,2,2] row_mask:0xf bank_mask:0xf
v_mov_b32_dpp v161, v44 quad_perm:[0,0,0,0] row_mask:0xf bank_mask:0xf
s_cmp_gt_u32 s54, 6
s_cbranch_scc1 L_b93
s_waitcnt vmcnt(4)
L_b93:
s_waitcnt vmcnt(6)
buffer_load_dwordx4 v[108:111], v1, s[12:15], s48 offen offset:256 nt
v_mfma_f32_16x16x32_bf16 v[52:55], v[80:83], v[32:35], 0
v_add_f32_dpp v160, v43, v160 quad_perm:[3,3,3,3] row_mask:0xf bank_mask:0xf
v_add_f32_dpp v161, v45, v161 quad_perm:[1,1,1,1] row_mask:0xf bank_mask:0xf
s_cmp_gt_u32 s54, 7
s_cbranch_scc1 L_b94
s_waitcnt vmcnt(4)
L_b94:
s_waitcnt vmcnt(6)
s_xor_b32 s48, s47, 0x136000
buffer_load_dwordx4 v[112:115], v1, s[12:15], s48 offen offset:0 nt
v_mfma_f32_16x16x32_bf16 v[52:55], v[84:87], v[36:39], v[52:55]
v_add_f32_dpp v161, v46, v161 quad_perm:[2,2,2,2] row_mask:0xf bank_mask:0xf
v_mov_b32_dpp v162, v48 quad_perm:[0,0,0,0] row_mask:0xf bank_mask:0xf
s_cmp_gt_u32 s54, 8
s_cbranch_scc1 L_b95
s_waitcnt vmcnt(4)
L_b95:
s_waitcnt vmcnt(6)
buffer_load_dwordx4 v[116:119], v1, s[12:15], s48 offen offset:256 nt
v_mfma_f32_16x16x32_bf16 v[40:43], v[88:91], v[32:35], 0
v_add_f32_dpp v161, v47, v161 quad_perm:[3,3,3,3] row_mask:0xf bank_mask:0xf
v_add_f32_dpp v162, v49, v162 quad_perm:[1,1,1,1] row_mask:0xf bank_mask:0xf
s_cmp_gt_u32 s54, 9
s_cbranch_scc1 L_b96
s_waitcnt vmcnt(4)
L_b96:
s_waitcnt vmcnt(6)
s_xor_b32 s48, s47, 0x140000
buffer_load_dwordx4 v[56:59], v1, s[12:15], s48 offen offset:0 nt
v_mfma_f32_16x16x32_bf16 v[40:43], v[92:95], v[36:39], v[40:43]
v_max3_f32 v9, v160, v161, v9
v_add_f32_dpp v162, v50, v162 quad_perm:[2,2,2,2] row_mask:0xf bank_mask:0xf
v_mov_b32_dpp v163, v52 quad_perm:[0,0,0,0] row_mask:0xf bank_mask:0xf
s_cmp_gt_u32 s54, 10
s_cbranch_scc1 L_b97
s_waitcnt vmcnt(4)
L_b97:
s_waitcnt vmcnt(6)
buffer_load_dwordx4 v[60:63], v1, s[12:15], s48 offen offset:256 nt
v_mfma_f32_16x16x32_bf16 v[44:47], v[96:99], v[32:35], 0
v_add_f32_dpp v162, v51, v162 quad_perm:[3,3,3,3] row_mask:0xf bank_mask:0xf
v_add_f32_dpp v163, v53, v163 quad_perm:[1,1,1,1] row_mask:0xf bank_mask:0xf
s_cmp_gt_u32 s54, 11
s_cbranch_scc1 L_b98
s_waitcnt vmcnt(4)
L_b98:
s_waitcnt vmcnt(6)
s_xor_b32 s48, s47, 0x142000
buffer_load_dwordx4 v[64:67], v1, s[12:15], s48 offen offset:0 nt
v_mfma_f32_16x16x32_bf16 v[44:47], v[100:103], v[36:39], v[44:47]
v_add_f32_dpp v163, v54, v163 quad_perm:[2,2,2,2] row_mask:0xf bank_mask:0xf
v_mov_b32_dpp v164, v40 quad_perm:[0,0,0,0] row_mask:0xf bank_mask:0xf
s_cmp_gt_u32 s54, 12
s_cbranch_scc1 L_b99
s_waitcnt vmcnt(4)
L_b99:
s_waitcnt vmcnt(6)
buffer_load_dwordx4 v[68:71], v1, s[12:15], s48 offen offset:256 nt
v_mfma_f32_16x16x32_bf16 v[48:51], v[104:107], v[32:35], 0
v_add_f32_dpp v163, v55, v163 quad_perm:[3,3,3,3] row_mask:0xf bank_mask:0xf
v_add_f32_dpp v164, v41, v164 quad_perm:[1,1,1,1] row_mask:0xf bank_mask:0xf
s_cmp_gt_u32 s54, 13
s_cbranch_scc1 L_b100
s_waitcnt vmcnt(4)
L_b100:
s_waitcnt vmcnt(6)
s_xor_b32 s48, s47, 0x144000
buffer_load_dwordx4 v[72:75], v1, s[12:15], s48 offen offset:0 nt
v_mfma_f32_16x16x32_bf16 v[48:51], v[108:111], v[36:39], v[48:51]
v_max3_f32 v9, v162, v163, v9
v_add_f32_dpp v164, v42, v164 quad_perm:[2,2,2,2] row_mask:0xf bank_mask:0xf
v_mov_b32_dpp v165, v44 quad_perm:[0,0,0,0] row_mask:0xf bank_mask:0xf
s_cmp_gt_u32 s54, 14
s_cbranch_scc1 L_b101
s_waitcnt vmcnt(4)
L_b101:
s_waitcnt vmcnt(6)
buffer_load_dwordx4 v[76:79], v1, s[12:15], s48 offen offset:256 nt
v_mfma_f32_16x16x32_bf16 v[52:55], v[112:115], v[32:35], 0
v_add_f32_dpp v164, v43, v164 quad_perm:[3,3,3,3] row_mask:0xf bank_mask:0xf
v_add_f32_dpp v165, v45, v165 quad_perm:[1,1,1,1] row_mask:0xf bank_mask:0xf
s_cmp_gt_u32 s54, 15
s_cbranch_scc1 L_b102
s_waitcnt vmcnt(4)
L_b102:
s_waitcnt vmcnt(6)
s_xor_b32 s48, s47, 0x146000
buffer_load_dwordx4 v[80:83], v1, s[12:15], s48 offen offset:0 nt
v_mfma_f32_16x16x32_bf16 v[52:55], v[116:119], v[36:39], v[52:55]
v_add_f32_dpp v165, v46, v165 quad_perm:[2,2,2,2] row_mask:0xf bank_mask:0xf
v_mov_b32_dpp v166, v48 quad_perm:[0,0,0,0] row_mask:0xf bank_mask:0xf
s_cmp_gt_u32 s54, 16
s_cbranch_scc1 L_b103
s_waitcnt vmcnt(4)
L_b103:
s_waitcnt vmcnt(6)
buffer_load_dwordx4 v[84:87], v1, s[12:15], s48 offen offset:256 nt
v_mfma_f32_16x16x32_bf16 v[40:43], v[56:59], v[32:35], 0
v_add_f32_dpp v165, v47, v165 quad_perm:[3,3,3,3] row_mask:0xf bank_mask:0xf
v_add_f32_dpp v166, v49, v166 quad_perm:[1,1,1,1] row_mask:0xf bank_mask:0xf
s_cmp_gt_u32 s54, 17
s_cbranch_scc1 L_b104
s_waitcnt vmcnt(4)
L_b104:
s_waitcnt vmcnt(6)
s_xor_b32 s48, s47, 0x150000
buffer_load_dwordx4 v[88:91], v1, s[12:15], s48 offen offset:0 nt
v_mfma_f32_16x16x32_bf16 v[40:43], v[60:63], v[36:39], v[40:43]
v_max3_f32 v9, v164, v165, v9
v_add_f32_dpp v166, v50, v166 quad_perm:[2,2,2,2] row_mask:0xf bank_mask:0xf
v_mov_b32_dpp v167, v52 quad_perm:[0,0,0,0] row_mask:0xf bank_mask:0xf
s_cmp_gt_u32 s54, 18
s_cbranch_scc1 L_b105
s_waitcnt vmcnt(4)
L_b105:
s_waitcnt vmcnt(6)
buffer_load_dwordx4 v[92:95], v1, s[12:15], s48 offen offset:256 nt
v_mfma_f32_16x16x32_bf16 v[44:47], v[64:67], v[32:35], 0
v_add_f32_dpp v166, v51, v166 quad_perm:[3,3,3,3] row_mask:0xf bank_mask:0xf
v_add_f32_dpp v167, v53, v167 quad_perm:[1,1,1,1] row_mask:0xf bank_mask:0xf
s_cmp_gt_u32 s54, 19
s_cbranch_scc1 L_b106
s_waitcnt vmcnt(4)
L_b106:
s_waitcnt vmcnt(6)
s_xor_b32 s48, s47, 0x152000
buffer_load_dwordx4 v[96:99], v1, s[12:15], s48 offen offset:0 nt
v_mfma_f32_16x16x32_bf16 v[44:47], v[68:71], v[36:39], v[44:47]
v_add_f32_dpp v167, v54, v167 quad_perm:[2,2,2,2] row_mask:0xf bank_mask:0xf
v_mov_b32_dpp v168, v40 quad_perm:[0,0,0,0] row_mask:0xf bank_mask:0xf
s_cmp_gt_u32 s54, 20
s_cbranch_scc1 L_b107
s_waitcnt vmcnt(4)
L_b107:
s_waitcnt vmcnt(6)
buffer_load_dwordx4 v[100:103], v1, s[12:15], s48 offen offset:256 nt
v_mfma_f32_16x16x32_bf16 v[48:51], v[72:75], v[32:35], 0
v_add_f32_dpp v167, v55, v167 quad_perm:[3,3,3,3] row_mask:0xf bank_mask:0xf
v_add_f32_dpp v168, v41, v168 quad_perm:[1,1,1,1] row_mask:0xf bank_mask:0xf
s_cmp_gt_u32 s54, 21
s_cbranch_scc1 L_b108
s_waitcnt vmcnt(4)
L_b108:
s_waitcnt vmcnt(6)
s_xor_b32 s48, s47, 0x154000
buffer_load_dwordx4 v[104:107], v1, s[12:15], s48 offen offset:0 nt
v_mfma_f32_16x16x32_bf16 v[48:51], v[76:79], v[36:39], v[48:51]
v_max3_f32 v9, v166, v167, v9
v_add_f32_dpp v168, v42, v168 quad_perm:[2,2,2,2] row_mask:0xf bank_mask:0xf
v_mov_b32_dpp v169, v44 quad_perm:[0,0,0,0] row_mask:0xf bank_mask:0xf
s_cmp_gt_u32 s54, 22
s_cbranch_scc1 L_b109
s_waitcnt vmcnt(4)
L_b109:
s_waitcnt vmcnt(6)
buffer_load_dwordx4 v[108:111], v1, s[12:15], s48 offen offset:256 nt
v_mfma_f32_16x16x32_bf16 v[52:55], v[80:83], v[32:35], 0
v_add_f32_dpp v168, v43, v168 quad_perm:[3,3,3,3] row_mask:0xf bank_mask:0xf
v_add_f32_dpp v169, v45, v169 quad_perm:[1,1,1,1] row_mask:0xf bank_mask:0xf
s_cmp_gt_u32 s54, 23
s_cbranch_scc1 L_b110
s_waitcnt vmcnt(4)
L_b110:
s_waitcnt vmcnt(6)
s_xor_b32 s48, s47, 0x156000
buffer_load_dwordx4 v[112:115], v1, s[12:15], s48 offen offset:0 nt
v_mfma_f32_16x16x32_bf16 v[52:55], v[84:87], v[36:39], v[52:55]
v_add_f32_dpp v169, v46, v169 quad_perm:[2,2,2,2] row_mask:0xf bank_mask:0xf
v_mov_b32_dpp v170, v48 quad_perm:[0,0,0,0] row_mask:0xf bank_mask:0xf
s_cmp_gt_u32 s54, 24
s_cbranch_scc1 L_b111
s_waitcnt vmcnt(4)
L_b111:
s_waitcnt vmcnt(6)
buffer_load_dwordx4 v[116:119], v1, s[12:15], s48 offen offset:256 nt
v_mfma_f32_16x16x32_bf16 v[40:43], v[88:91], v[32:35], 0
v_add_f32_dpp v169, v47, v169 quad_perm:[3,3,3,3] row_mask:0xf bank_mask:0xf
v_add_f32_dpp v170, v49, v170 quad_perm:[1,1,1,1] row_mask:0xf bank_mask:0xf
s_cmp_gt_u32 s54, 25
s_cbranch_scc1 L_b112
s_waitcnt vmcnt(4)
L_b112:
s_waitcnt vmcnt(6)
s_xor_b32 s48, s47, 0x160000
buffer_load_dwordx4 v[56:59], v1, s[12:15], s48 offen offset:0 nt
v_mfma_f32_16x16x32_bf16 v[40:43], v[92:95], v[36:39], v[40:43]
v_max3_f32 v9, v168, v169, v9
v_add_f32_dpp v170, v50, v170 quad_perm:[2,2,2,2] row_mask:0xf bank_mask:0xf
v_mov_b32_dpp v171, v52 quad_perm:[0,0,0,0] row_mask:0xf bank_mask:0xf
s_waitcnt vmcnt(4)
buffer_load_dwordx4 v[60:63], v1, s[12:15], s48 offen offset:256 nt
v_mfma_f32_16x16x32_bf16 v[44:47], v[96:99], v[32:35], 0
v_add_f32_dpp v170, v51, v170 quad_perm:[3,3,3,3] row_mask:0xf bank_mask:0xf
v_add_f32_dpp v171, v53, v171 quad_perm:[1,1,1,1] row_mask:0xf bank_mask:0xf
s_waitcnt vmcnt(4)
s_xor_b32 s48, s47, 0x162000
buffer_load_dwordx4 v[64:67], v1, s[12:15], s48 offen offset:0 nt
v_mfma_f32_16x16x32_bf16 v[44:47], v[100:103], v[36:39], v[44:47]
v_add_f32_dpp v171, v54, v171 quad_perm:[2,2,2,2] row_mask:0xf bank_mask:0xf
v_mov_b32_dpp v172, v40 quad_perm:[0,0,0,0] row_mask:0xf bank_mask:0xf
s_waitcnt vmcnt(4)
buffer_load_dwordx4 v[68:71], v1, s[12:15], s48 offen offset:256 nt
v_mfma_f32_16x16x32_bf16 v[48:51], v[104:107], v[32:35], 0
v_add_f32_dpp v171, v55, v171 quad_perm:[3,3,3,3] row_mask:0xf bank_mask:0xf
v_add_f32_dpp v172, v41, v172 quad_perm:[1,1,1,1] row_mask:0xf bank_mask:0xf
s_waitcnt vmcnt(4)
s_xor_b32 s48, s47, 0x164000
buffer_load_dwordx4 v[72:75], v1, s[12:15], s48 offen offset:0 nt
v_mfma_f32_16x16x32_bf16 v[48:51], v[108:111], v[36:39], v[48:51]
v_max3_f32 v9, v170, v171, v9
v_add_f32_dpp v172, v42, v172 quad_perm:[2,2,2,2] row_mask:0xf bank_mask:0xf
v_mov_b32_dpp v173, v44 quad_perm:[0,0,0,0] row_mask:0xf bank_mask:0xf
s_waitcnt vmcnt(4)
buffer_load_dwordx4 v[76:79], v1, s[12:15], s48 offen offset:256 nt
v_mfma_f32_16x16x32_bf16 v[52:55], v[112:115], v[32:35], 0
v_add_f32_dpp v172, v43, v172 quad_perm:[3,3,3,3] row_mask:0xf bank_mask:0xf
v_add_f32_dpp v173, v45, v173 quad_perm:[1,1,1,1] row_mask:0xf bank_mask:0xf
s_waitcnt vmcnt(4)
s_xor_b32 s48, s47, 0x166000
buffer_load_dwordx4 v[80:83], v1, s[12:15], s48 offen offset:0 nt
v_mfma_f32_16x16x32_bf16 v[52:55], v[116:119], v[36:39], v[52:55]
v_add_f32_dpp v173, v46, v173 quad_perm:[2,2,2,2] row_mask:0xf bank_mask:0xf
v_mov_b32_dpp v174, v48 quad_perm:[0,0,0,0] row_mask:0xf bank_mask:0xf
s_waitcnt vmcnt(4)
buffer_load_dwordx4 v[84:87], v1, s[12:15], s48 offen offset:256 nt
v_mfma_f32_16x16x32_bf16 v[40:43], v[56:59], v[32:35], 0
v_add_f32_dpp v173, v47, v173 quad_perm:[3,3,3,3] row_mask:0xf bank_mask:0xf
v_add_f32_dpp v174, v49, v174 quad_perm:[1,1,1,1] row_mask:0xf bank_mask:0xf
s_waitcnt vmcnt(4)
s_xor_b32 s48, s47, 0x170000
buffer_load_dwordx4 v[88:91], v1, s[12:15], s48 offen offset:0 nt
v_mfma_f32_16x16x32_bf16 v[40:43], v[60:63], v[36:39], v[40:43]
v_max3_f32 v9, v172, v173, v9
v_add_f32_dpp v174, v50, v174 quad_perm:[2,2,2,2] row_mask:0xf bank_mask:0xf
v_mov_b32_dpp v175, v52 quad_perm:[0,0,0,0] row_mask:0xf bank_mask:0xf
s_waitcnt vmcnt(4)
buffer_load_dwordx4 v[92:95], v1, s[12:15], s48 offen offset:256 nt
v_mfma_f32_16x16x32_bf16 v[44:47], v[64:67], v[32:35], 0
v_add_f32_dpp v174, v51, v174 quad_perm:[3,3,3,3] row_mask:0xf bank_mask:0xf
v_add_f32_dpp v175, v53, v175 quad_perm:[1,1,1,1] row_mask:0xf bank_mask:0xf
s_waitcnt vmcnt(4)
s_xor_b32 s48, s47, 0x172000
buffer_load_dwordx4 v[96:99], v1, s[12:15], s48 offen offset:0 nt
v_mfma_f32_16x16x32_bf16 v[44:47], v[68:71], v[36:39], v[44:47]
v_add_f32_dpp v175, v54, v175 quad_perm:[2,2,2,2] row_mask:0xf bank_mask:0xf
v_mov_b32_dpp v176, v40 quad_perm:[0,0,0,0] row_mask:0xf bank_mask:0xf
s_waitcnt vmcnt(4)
buffer_load_dwordx4 v[100:103], v1, s[12:15], s48 offen offset:256 nt
v_mfma_f32_16x16x32_bf16 v[48:51], v[72:75], v[32:35], 0
v_add_f32_dpp v175, v55, v175 quad_perm:[3,3,3,3] row_mask:0xf bank_mask:0xf
v_add_f32_dpp v176, v41, v176 quad_perm:[1,1,1,1] row_mask:0xf bank_mask:0xf
s_waitcnt vmcnt(4)
s_xor_b32 s48, s47, 0x174000
buffer_load_dwordx4 v[104:107], v1, s[12:15], s48 offen offset:0 nt
v_mfma_f32_16x16x32_bf16 v[48:51], v[76:79], v[36:39], v[48:51]
v_max3_f32 v9, v174, v175, v9
v_add_f32_dpp v176, v42, v176 quad_perm:[2,2,2,2] row_mask:0xf bank_mask:0xf
v_mov_b32_dpp v177, v44 quad_perm:[0,0,0,0] row_mask:0xf bank_mask:0xf
s_waitcnt vmcnt(4)
buffer_load_dwordx4 v[108:111], v1, s[12:15], s48 offen offset:256 nt
v_mfma_f32_16x16x32_bf16 v[52:55], v[80:83], v[32:35], 0
v_add_f32_dpp v176, v43, v176 quad_perm:[3,3,3,3] row_mask:0xf bank_mask:0xf
v_add_f32_dpp v177, v45, v177 quad_perm:[1,1,1,1] row_mask:0xf bank_mask:0xf
s_waitcnt vmcnt(4)
s_xor_b32 s48, s47, 0x176000
buffer_load_dwordx4 v[112:115], v1, s[12:15], s48 offen offset:0 nt
v_mfma_f32_16x16x32_bf16 v[52:55], v[84:87], v[36:39], v[52:55]
v_add_f32_dpp v177, v46, v177 quad_perm:[2,2,2,2] row_mask:0xf bank_mask:0xf
v_mov_b32_dpp v178, v48 quad_perm:[0,0,0,0] row_mask:0xf bank_mask:0xf
s_waitcnt vmcnt(4)
buffer_load_dwordx4 v[116:119], v1, s[12:15], s48 offen offset:256 nt
v_mfma_f32_16x16x32_bf16 v[40:43], v[88:91], v[32:35], 0
v_add_f32_dpp v177, v47, v177 quad_perm:[3,3,3,3] row_mask:0xf bank_mask:0xf
v_add_f32_dpp v178, v49, v178 quad_perm:[1,1,1,1] row_mask:0xf bank_mask:0xf
s_waitcnt vmcnt(4)
buffer_load_dwordx4 v[56:59], v2, s[16:19], s47 offen offset:0 nt
v_mfma_f32_16x16x32_bf16 v[40:43], v[92:95], v[36:39], v[40:43]
v_max3_f32 v9, v176, v177, v9
v_add_f32_dpp v178, v50, v178 quad_perm:[2,2,2,2] row_mask:0xf bank_mask:0xf
v_mov_b32_dpp v179, v52 quad_perm:[0,0,0,0] row_mask:0xf bank_mask:0xf
s_waitcnt vmcnt(4)
buffer_load_dwordx4 v[60:63], v2, s[16:19], s47 offen offset:256 nt
v_mfma_f32_16x16x32_bf16 v[44:47], v[96:99], v[32:35], 0
v_add_f32_dpp v178, v51, v178 quad_perm:[3,3,3,3] row_mask:0xf bank_mask:0xf
v_add_f32_dpp v179, v53, v179 quad_perm:[1,1,1,1] row_mask:0xf bank_mask:0xf
s_waitcnt vmcnt(4)
s_xor_b32 s48, s47, 0x2000
buffer_load_dwordx4 v[64:67], v2, s[16:19], s48 offen offset:0 nt
v_mfma_f32_16x16x32_bf16 v[44:47], v[100:103], v[36:39], v[44:47]
v_add_f32_dpp v179, v54, v179 quad_perm:[2,2,2,2] row_mask:0xf bank_mask:0xf
v_mov_b32_dpp v180, v40 quad_perm:[0,0,0,0] row_mask:0xf bank_mask:0xf
s_waitcnt vmcnt(4)
buffer_load_dwordx4 v[68:71], v2, s[16:19], s48 offen offset:256 nt
v_mfma_f32_16x16x32_bf16 v[48:51], v[104:107], v[32:35], 0
v_add_f32_dpp v179, v55, v179 quad_perm:[3,3,3,3] row_mask:0xf bank_mask:0xf
v_add_f32_dpp v180, v41, v180 quad_perm:[1,1,1,1] row_mask:0xf bank_mask:0xf
s_waitcnt vmcnt(4)
s_xor_b32 s48, s47, 0x4000
buffer_load_dwordx4 v[72:75], v2, s[16:19], s48 offen offset:0 nt
v_mfma_f32_16x16x32_bf16 v[48:51], v[108:111], v[36:39], v[48:51]
v_max3_f32 v9, v178, v179, v9
v_add_f32_dpp v180, v42, v180 quad_perm:[2,2,2,2] row_mask:0xf bank_mask:0xf
v_mov_b32_dpp v181, v44 quad_perm:[0,0,0,0] row_mask:0xf bank_mask:0xf
s_waitcnt vmcnt(4)
buffer_load_dwordx4 v[76:79], v2, s[16:19], s48 offen offset:256 nt
v_mfma_f32_16x16x32_bf16 v[52:55], v[112:115], v[32:35], 0
v_add_f32_dpp v180, v43, v180 quad_perm:[3,3,3,3] row_mask:0xf bank_mask:0xf
v_add_f32_dpp v181, v45, v181 quad_perm:[1,1,1,1] row_mask:0xf bank_mask:0xf
s_waitcnt vmcnt(4)
s_xor_b32 s48, s47, 0x6000
buffer_load_dwordx4 v[80:83], v2, s[16:19], s48 offen offset:0 nt
v_mfma_f32_16x16x32_bf16 v[52:55], v[116:119], v[36:39], v[52:55]
v_add_f32_dpp v181, v46, v181 quad_perm:[2,2,2,2] row_mask:0xf bank_mask:0xf
v_mov_b32_dpp v182, v48 quad_perm:[0,0,0,0] row_mask:0xf bank_mask:0xf
s_nop 2
v_add_f32_dpp v181, v47, v181 quad_perm:[3,3,3,3] row_mask:0xf bank_mask:0xf
v_add_f32_dpp v182, v49, v182 quad_perm:[1,1,1,1] row_mask:0xf bank_mask:0xf
s_nop 2
v_max3_f32 v9, v180, v181, v9
v_add_f32_dpp v182, v50, v182 quad_perm:[2,2,2,2] row_mask:0xf bank_mask:0xf
v_mov_b32_dpp v183, v52 quad_perm:[0,0,0,0] row_mask:0xf bank_mask:0xf
s_nop 1
v_add_f32_dpp v182, v51, v182 quad_perm:[3,3,3,3] row_mask:0xf bank_mask:0xf
v_add_f32_dpp v183, v53, v183 quad_perm:[1,1,1,1] row_mask:0xf bank_mask:0xf
s_nop 1
v_add_f32_dpp v183, v54, v183 quad_perm:[2,2,2,2] row_mask:0xf bank_mask:0xf
s_nop 1
v_add_f32_dpp v183, v55, v183 quad_perm:[3,3,3,3] row_mask:0xf bank_mask:0xf
s_nop 1
v_max3_f32 v9, v182, v183, v9
v_mov_b32 v28, v9
s_nop 1
v_permlane32_swap_b32 v9, v28
s_nop 1
v_max_f32 v9, v9, v28
v_mov_b32 v28, v9
s_nop 1
v_permlane16_swap_b32 v9, v28
s_nop 1
v_max_f32 v9, v9, v28
v_sub_f32 v28, v120, v9
v_sub_f32 v29, v121, v9
v_mul_f32 v28, s49, v28
v_mul_f32 v29, s49, v29
v_exp_f32 v28, v28
v_exp_f32 v29, v29
v_cvt_pk_bf16_f32 v120, v28, v28
v_add_f32 v8, v8, v28
v_cvt_pk_bf16_f32 v121, v29, v29
v_add_f32 v8, v8, v29
v_and_b32 v20, v120, v4
v_and_b32 v21, v120, v5
v_and_b32 v22, v120, v6
v_and_b32 v23, v120, v7
s_nop 1
s_waitcnt vmcnt(4)
buffer_load_dwordx4 v[84:87], v2, s[16:19], s48 offen offset:256 nt
v_mfma_f32_16x16x32_bf16 v[12:15], v[20:23], v[56:59], v[12:15]
v_and_b32 v24, v121, v4
v_and_b32 v25, v121, v5
v_and_b32 v26, v121, v6
v_and_b32 v27, v121, v7
s_waitcnt vmcnt(4)
s_xor_b32 s48, s47, 0x10000
buffer_load_dwordx4 v[88:91], v2, s[16:19], s48 offen offset:0 nt
v_mfma_f32_16x16x32_bf16 v[16:19], v[20:23], v[60:63], v[16:19]
v_sub_f32 v28, v122, v9
v_sub_f32 v29, v123, v9
v_mul_f32 v28, s49, v28
v_mul_f32 v29, s49, v29
v_exp_f32 v28, v28
v_exp_f32 v29, v29
v_cvt_pk_bf16_f32 v122, v28, v28
v_add_f32 v8, v8, v28
v_cvt_pk_bf16_f32 v123, v29, v29
v_add_f32 v8, v8, v29
s_waitcnt vmcnt(4)
buffer_load_dwordx4 v[92:95], v2, s[16:19], s48 offen offset:256 nt
v_mfma_f32_16x16x32_bf16 v[12:15], v[24:27], v[64:67], v[12:15]
v_and_b32 v20, v122, v4
v_and_b32 v21, v122, v5
v_and_b32 v22, v122, v6
v_and_b32 v23, v122, v7
s_waitcnt vmcnt(4)
s_xor_b32 s48, s47, 0x12000
buffer_load_dwordx4 v[96:99], v2, s[16:19], s48 offen offset:0 nt
v_mfma_f32_16x16x32_bf16 v[16:19], v[24:27], v[68:71], v[16:19]
v_sub_f32 v28, v124, v9
v_sub_f32 v29, v125, v9
v_mul_f32 v28, s49, v28
v_mul_f32 v29, s49, v29
v_exp_f32 v28, v28
v_exp_f32 v29, v29
v_cvt_pk_bf16_f32 v124, v28, v28
v_add_f32 v8, v8, v28
v_cvt_pk_bf16_f32 v125, v29, v29
v_add_f32 v8, v8, v29
s_waitcnt vmcnt(4)
buffer_load_dwordx4 v[100:103], v2, s[16:19], s48 offen offset:256 nt
v_mfma_f32_16x16x32_bf16 v[12:15], v[20:23], v[72:75], v[12:15]
v_and_b32 v24, v123, v4
v_and_b32 v25, v123, v5
v_and_b32 v26, v123, v6
v_and_b32 v27, v123, v7
s_waitcnt vmcnt(4)
s_xor_b32 s48, s47, 0x14000
buffer_load_dwordx4 v[104:107], v2, s[16:19], s48 offen offset:0 nt
v_mfma_f32_16x16x32_bf16 v[16:19], v[20:23], v[76:79], v[16:19]
v_sub_f32 v28, v126, v9
v_sub_f32 v29, v127, v9
v_mul_f32 v28, s49, v28
v_mul_f32 v29, s49, v29
v_exp_f32 v28, v28
v_exp_f32 v29, v29
v_cvt_pk_bf16_f32 v126, v28, v28
v_add_f32 v8, v8, v28
v_cvt_pk_bf16_f32 v127, v29, v29
v_add_f32 v8, v8, v29
s_waitcnt vmcnt(4)
buffer_load_dwordx4 v[108:111], v2, s[16:19], s48 offen offset:256 nt
v_mfma_f32_16x16x32_bf16 v[12:15], v[24:27], v[80:83], v[12:15]
v_and_b32 v20, v124, v4
v_and_b32 v21, v124, v5
v_and_b32 v22, v124, v6
v_and_b32 v23, v124, v7
s_waitcnt vmcnt(4)
s_xor_b32 s48, s47, 0x16000
buffer_load_dwordx4 v[112:115], v2, s[16:19], s48 offen offset:0 nt
v_mfma_f32_16x16x32_bf16 v[16:19], v[24:27], v[84:87], v[16:19]
v_sub_f32 v28, v128, v9
v_sub_f32 v29, v129, v9
v_mul_f32 v28, s49, v28
v_mul_f32 v29, s49, v29
v_exp_f32 v28, v28
v_exp_f32 v29, v29
v_cvt_pk_bf16_f32 v128, v28, v28
v_add_f32 v8, v8, v28
v_cvt_pk_bf16_f32 v129, v29, v29
v_add_f32 v8, v8, v29
s_waitcnt vmcnt(4)
buffer_load_dwordx4 v[116:119], v2, s[16:19], s48 offen offset:256 nt
v_mfma_f32_16x16x32_bf16 v[12:15], v[20:23], v[88:91], v[12:15]
v_and_b32 v24, v125, v4
v_and_b32 v25, v125, v5
v_and_b32 v26, v125, v6
v_and_b32 v27, v125, v7
s_waitcnt vmcnt(4)
s_xor_b32 s48, s47, 0x20000
buffer_load_dwordx4 v[56:59], v2, s[16:19], s48 offen offset:0 nt
v_mfma_f32_16x16x32_bf16 v[16:19], v[20:23], v[92:95], v[16:19]
v_sub_f32 v28, v130, v9
v_sub_f32 v29, v131, v9
v_mul_f32 v28, s49, v28
v_mul_f32 v29, s49, v29
v_exp_f32 v28, v28
v_exp_f32 v29, v29
v_cvt_pk_bf16_f32 v130, v28, v28
v_add_f32 v8, v8, v28
v_cvt_pk_bf16_f32 v131, v29, v29
v_add_f32 v8, v8, v29
s_waitcnt vmcnt(4)
buffer_load_dwordx4 v[60:63], v2, s[16:19], s48 offen offset:256 nt
v_mfma_f32_16x16x32_bf16 v[12:15], v[24:27], v[96:99], v[12:15]
v_and_b32 v20, v126, v4
v_and_b32 v21, v126, v5
v_and_b32 v22, v126, v6
v_and_b32 v23, v126, v7
s_waitcnt vmcnt(4)
s_xor_b32 s48, s47, 0x22000
buffer_load_dwordx4 v[64:67], v2, s[16:19], s48 offen offset:0 nt
v_mfma_f32_16x16x32_bf16 v[16:19], v[24:27], v[100:103], v[16:19]
v_sub_f32 v28, v132, v9
v_sub_f32 v29, v133, v9
v_mul_f32 v28, s49, v28
v_mul_f32 v29, s49, v29
v_exp_f32 v28, v28
v_exp_f32 v29, v29
v_cvt_pk_bf16_f32 v132, v28, v28
v_add_f32 v8, v8, v28
v_cvt_pk_bf16_f32 v133, v29, v29
v_add_f32 v8, v8, v29
s_waitcnt vmcnt(4)
buffer_load_dwordx4 v[68:71], v2, s[16:19], s48 offen offset:256 nt
v_mfma_f32_16x16x32_bf16 v[12:15], v[20:23], v[104:107], v[12:15]
v_and_b32 v24, v127, v4
v_and_b32 v25, v127, v5
v_and_b32 v26, v127, v6
v_and_b32 v27, v127, v7
s_waitcnt vmcnt(4)
s_xor_b32 s48, s47, 0x24000
buffer_load_dwordx4 v[72:75], v2, s[16:19], s48 offen offset:0 nt
v_mfma_f32_16x16x32_bf16 v[16:19], v[20:23], v[108:111], v[16:19]
v_sub_f32 v28, v134, v9
v_sub_f32 v29, v135, v9
v_mul_f32 v28, s49, v28
v_mul_f32 v29, s49, v29
v_exp_f32 v28, v28
v_exp_f32 v29, v29
v_cvt_pk_bf16_f32 v134, v28, v28
v_add_f32 v8, v8, v28
v_cvt_pk_bf16_f32 v135, v29, v29
v_add_f32 v8, v8, v29
s_waitcnt vmcnt(4)
buffer_load_dwordx4 v[76:79], v2, s[16:19], s48 offen offset:256 nt
v_mfma_f32_16x16x32_bf16 v[12:15], v[24:27], v[112:115], v[12:15]
v_and_b32 v20, v128, v4
v_and_b32 v21, v128, v5
v_and_b32 v22, v128, v6
v_and_b32 v23, v128, v7
s_waitcnt vmcnt(4)
s_xor_b32 s48, s47, 0x26000
buffer_load_dwordx4 v[80:83], v2, s[16:19], s48 offen offset:0 nt
buffer_load_ushort v30, v184, s[28:31], s50 offen offset:128 nt
buffer_store_byte v186, v185, s[28:31], s50 offen offset:128
v_mfma_f32_16x16x32_bf16 v[16:19], v[24:27], v[116:119], v[16:19]
v_sub_f32 v28, v136, v9
v_sub_f32 v29, v137, v9
v_mul_f32 v28, s49, v28
v_mul_f32 v29, s49, v29
v_exp_f32 v28, v28
v_exp_f32 v29, v29
v_cvt_pk_bf16_f32 v136, v28, v28
v_add_f32 v8, v8, v28
v_cvt_pk_bf16_f32 v137, v29, v29
v_add_f32 v8, v8, v29
s_waitcnt vmcnt(6)
buffer_load_dwordx4 v[84:87], v2, s[16:19], s48 offen offset:256 nt
v_mfma_f32_16x16x32_bf16 v[12:15], v[20:23], v[56:59], v[12:15]
v_and_b32 v24, v129, v4
v_and_b32 v25, v129, v5
v_and_b32 v26, v129, v6
v_and_b32 v27, v129, v7
s_waitcnt vmcnt(6)
s_xor_b32 s48, s47, 0x30000
buffer_load_dwordx4 v[88:91], v2, s[16:19], s48 offen offset:0 nt
v_mfma_f32_16x16x32_bf16 v[16:19], v[20:23], v[60:63], v[16:19]
v_sub_f32 v28, v138, v9
v_sub_f32 v29, v139, v9
v_mul_f32 v28, s49, v28
v_mul_f32 v29, s49, v29
v_exp_f32 v28, v28
v_exp_f32 v29, v29
v_cvt_pk_bf16_f32 v138, v28, v28
v_add_f32 v8, v8, v28
v_cvt_pk_bf16_f32 v139, v29, v29
v_add_f32 v8, v8, v29
s_waitcnt vmcnt(6)
buffer_load_dwordx4 v[92:95], v2, s[16:19], s48 offen offset:256 nt
v_mfma_f32_16x16x32_bf16 v[12:15], v[24:27], v[64:67], v[12:15]
v_and_b32 v20, v130, v4
v_and_b32 v21, v130, v5
v_and_b32 v22, v130, v6
v_and_b32 v23, v130, v7
s_waitcnt vmcnt(6)
s_xor_b32 s48, s47, 0x32000
buffer_load_dwordx4 v[96:99], v2, s[16:19], s48 offen offset:0 nt
v_mfma_f32_16x16x32_bf16 v[16:19], v[24:27], v[68:71], v[16:19]
v_sub_f32 v28, v140, v9
v_sub_f32 v29, v141, v9
v_mul_f32 v28, s49, v28
v_mul_f32 v29, s49, v29
v_exp_f32 v28, v28
v_exp_f32 v29, v29
v_cvt_pk_bf16_f32 v140, v28, v28
v_add_f32 v8, v8, v28
v_cvt_pk_bf16_f32 v141, v29, v29
v_add_f32 v8, v8, v29
s_waitcnt vmcnt(6)
buffer_load_dwordx4 v[100:103], v2, s[16:19], s48 offen offset:256 nt
v_mfma_f32_16x16x32_bf16 v[12:15], v[20:23], v[72:75], v[12:15]
v_and_b32 v24, v131, v4
v_and_b32 v25, v131, v5
v_and_b32 v26, v131, v6
v_and_b32 v27, v131, v7
s_waitcnt vmcnt(4)
s_xor_b32 s48, s47, 0x34000
buffer_load_dwordx4 v[104:107], v2, s[16:19], s48 offen offset:0 nt
v_cmp_lt_u32 vcc, 0xff, v30
v_and_b32 v30, 0xff, v30
s_bcnt1_i32_b64 s54, vcc
v_cmp_ne_u32 vcc, 0, v30
s_nop 1
s_bcnt1_i32_b64 s55, vcc
s_add_u32 s54, s54, s55
s_sub_i32 s55, s54, 112
s_max_i32 s55, s55, 0
s_mul_i32 s55, s55, 10
s_sub_i32 s54, s54, 64
s_max_i32 s54, s54, 0
s_mul_i32 s54, s54, 4
s_add_u32 s54, s54, s55
s_lshr_b32 s54, s54, 4
v_mfma_f32_16x16x32_bf16 v[16:19], v[20:23], v[76:79], v[16:19]
v_sub_f32 v28, v142, v9
v_sub_f32 v29, v143, v9
v_mul_f32 v28, s49, v28
v_mul_f32 v29, s49, v29
v_exp_f32 v28, v28
v_exp_f32 v29, v29
v_cvt_pk_bf16_f32 v142, v28, v28
v_add_f32 v8, v8, v28
v_cvt_pk_bf16_f32 v143, v29, v29
v_add_f32 v8, v8, v29
s_cmp_gt_u32 s54, 0
s_cbranch_scc1 L_b157
s_waitcnt vmcnt(4)
L_b157:
buffer_load_dwordx4 v[108:111], v2, s[16:19], s48 offen offset:256 nt
v_mfma_f32_16x16x32_bf16 v[12:15], v[24:27], v[80:83], v[12:15]
v_and_b32 v20, v132, v4
v_and_b32 v21, v132, v5
v_and_b32 v22, v132, v6
v_and_b32 v23, v132, v7
s_cmp_gt_u32 s54, 1
s_cbranch_scc1 L_b158
s_waitcnt vmcnt(4)
L_b158:
s_xor_b32 s48, s47, 0x36000
buffer_load_dwordx4 v[112:115], v2, s[16:19], s48 offen offset:0 nt
v_mfma_f32_16x16x32_bf16 v[16:19], v[24:27], v[84:87], v[16:19]
v_sub_f32 v28, v144, v9
v_sub_f32 v29, v145, v9
v_mul_f32 v28, s49, v28
v_mul_f32 v29, s49, v29
v_exp_f32 v28, v28
v_exp_f32 v29, v29
v_cvt_pk_bf16_f32 v144, v28, v28
v_add_f32 v8, v8, v28
v_cvt_pk_bf16_f32 v145, v29, v29
v_add_f32 v8, v8, v29
s_cmp_gt_u32 s54, 2
s_cbranch_scc1 L_b159
s_waitcnt vmcnt(4)
L_b159:
s_waitcnt vmcnt(6)
buffer_load_dwordx4 v[116:119], v2, s[16:19], s48 offen offset:256 nt
v_mfma_f32_16x16x32_bf16 v[12:15], v[20:23], v[88:91], v[12:15]
v_and_b32 v24, v133, v4
v_and_b32 v25, v133, v5
v_and_b32 v26, v133, v6
v_and_b32 v27, v133, v7
s_cmp_gt_u32 s54, 3
s_cbranch_scc1 L_b160
s_waitcnt vmcnt(4)
L_b160:
s_waitcnt vmcnt(6)
s_xor_b32 s48, s47, 0x40000
buffer_load_dwordx4 v[56:59], v2, s[16:19], s48 offen offset:0 nt
v_mfma_f32_16x16x32_bf16 v[16:19], v[20:23], v[92:95], v[16:19]
v_sub_f32 v28, v146, v9
v_sub_f32 v29, v147, v9
v_mul_f32 v28, s49, v28
v_mul_f32 v29, s49, v29
v_exp_f32 v28, v28
v_exp_f32 v29, v29
v_cvt_pk_bf16_f32 v146, v28, v28
v_add_f32 v8, v8, v28
v_cvt_pk_bf16_f32 v147, v29, v29
v_add_f32 v8, v8, v29
s_cmp_gt_u32 s54, 4
s_cbranch_scc1 L_b161
s_waitcnt vmcnt(4)
L_b161:
s_waitcnt vmcnt(6)
buffer_load_dwordx4 v[60:63], v2, s[16:19], s48 offen offset:256 nt
v_mfma_f32_16x16x32_bf16 v[12:15], v[24:27], v[96:99], v[12:15]
v_and_b32 v20, v134, v4
v_and_b32 v21, v134, v5
v_and_b32 v22, v134, v6
v_and_b32 v23, v134, v7
s_cmp_gt_u32 s54, 5
s_cbranch_scc1 L_b162
s_waitcnt vmcnt(4)
L_b162:
s_waitcnt vmcnt(6)
s_xor_b32 s48, s47, 0x42000
buffer_load_dwordx4 v[64:67], v2, s[16:19], s48 offen offset:0 nt
v_mfma_f32_16x16x32_bf16 v[16:19], v[24:27], v[100:103], v[16:19]
v_sub_f32 v28, v148, v9
v_sub_f32 v29, v149, v9
v_mul_f32 v28, s49, v28
v_mul_f32 v29, s49, v29
v_exp_f32 v28, v28
v_exp_f32 v29, v29
v_cvt_pk_bf16_f32 v148, v28, v28
v_add_f32 v8, v8, v28
v_cvt_pk_bf16_f32 v149, v29, v29
v_add_f32 v8, v8, v29
s_cmp_gt_u32 s54, 6
s_cbranch_scc1 L_b163
s_waitcnt vmcnt(4)
L_b163:
s_waitcnt vmcnt(6)
buffer_load_dwordx4 v[68:71], v2, s[16:19], s48 offen offset:256 nt
v_mfma_f32_16x16x32_bf16 v[12:15], v[20:23], v[104:107], v[12:15]
v_and_b32 v24, v135, v4
v_and_b32 v25, v135, v5
v_and_b32 v26, v135, v6
v_and_b32 v27, v135, v7
s_cmp_gt_u32 s54, 7
s_cbranch_scc1 L_b164
s_waitcnt vmcnt(4)
L_b164:
s_waitcnt vmcnt(6)
s_xor_b32 s48, s47, 0x44000
buffer_load_dwordx4 v[72:75], v2, s[16:19], s48 offen offset:0 nt
v_mfma_f32_16x16x32_bf16 v[16:19], v[20:23], v[108:111], v[16:19]
v_sub_f32 v28, v150, v9
v_sub_f32 v29, v151, v9
v_mul_f32 v28, s49, v28
v_mul_f32 v29, s49, v29
v_exp_f32 v28, v28
v_exp_f32 v29, v29
v_cvt_pk_bf16_f32 v150, v28, v28
v_add_f32 v8, v8, v28
v_cvt_pk_bf16_f32 v151, v29, v29
v_add_f32 v8, v8, v29
s_cmp_gt_u32 s54, 8
s_cbranch_scc1 L_b165
s_waitcnt vmcnt(4)
L_b165:
s_waitcnt vmcnt(6)
buffer_load_dwordx4 v[76:79], v2, s[16:19], s48 offen offset:256 nt
v_mfma_f32_16x16x32_bf16 v[12:15], v[24:27], v[112:115], v[12:15]
v_and_b32 v20, v136, v4
v_and_b32 v21, v136, v5
v_and_b32 v22, v136, v6
v_and_b32 v23, v136, v7
s_cmp_gt_u32 s54, 9
s_cbranch_scc1 L_b166
s_waitcnt vmcnt(4)
L_b166:
s_waitcnt vmcnt(6)
s_xor_b32 s48, s47, 0x46000
buffer_load_dwordx4 v[80:83], v2, s[16:19], s48 offen offset:0 nt
v_mfma_f32_16x16x32_bf16 v[16:19], v[24:27], v[116:119], v[16:19]
v_sub_f32 v28, v152, v9
v_sub_f32 v29, v153, v9
v_mul_f32 v28, s49, v28
v_mul_f32 v29, s49, v29
v_exp_f32 v28, v28
v_exp_f32 v29, v29
v_cvt_pk_bf16_f32 v152, v28, v28
v_add_f32 v8, v8, v28
v_cvt_pk_bf16_f32 v153, v29, v29
v_add_f32 v8, v8, v29
s_cmp_gt_u32 s54, 10
s_cbranch_scc1 L_b167
s_waitcnt vmcnt(4)
L_b167:
s_waitcnt vmcnt(6)
buffer_load_dwordx4 v[84:87], v2, s[16:19], s48 offen offset:256 nt
v_mfma_f32_16x16x32_bf16 v[12:15], v[20:23], v[56:59], v[12:15]
v_and_b32 v24, v137, v4
v_and_b32 v25, v137, v5
v_and_b32 v26, v137, v6
v_and_b32 v27, v137, v7
s_cmp_gt_u32 s54, 11
s_cbranch_scc1 L_b168
s_waitcnt vmcnt(4)
L_b168:
s_waitcnt vmcnt(6)
s_xor_b32 s48, s47, 0x50000
buffer_load_dwordx4 v[88:91], v2, s[16:19], s48 offen offset:0 nt
v_mfma_f32_16x16x32_bf16 v[16:19], v[20:23], v[60:63], v[16:19]
v_sub_f32 v28, v154, v9
v_sub_f32 v29, v155, v9
v_mul_f32 v28, s49, v28
v_mul_f32 v29, s49, v29
v_exp_f32 v28, v28
v_exp_f32 v29, v29
v_cvt_pk_bf16_f32 v154, v28, v28
v_add_f32 v8, v8, v28
v_cvt_pk_bf16_f32 v155, v29, v29
v_add_f32 v8, v8, v29
s_cmp_gt_u32 s54, 12
s_cbranch_scc1 L_b169
s_waitcnt vmcnt(4)
L_b169:
s_waitcnt vmcnt(6)
buffer_load_dwordx4 v[92:95], v2, s[16:19], s48 offen offset:256 nt
v_mfma_f32_16x16x32_bf16 v[12:15], v[24:27], v[64:67], v[12:15]
v_and_b32 v20, v138, v4
v_and_b32 v21, v138, v5
v_and_b32 v22, v138, v6
v_and_b32 v23, v138, v7
s_cmp_gt_u32 s54, 13
s_cbranch_scc1 L_b170
s_waitcnt vmcnt(4)
L_b170:
s_waitcnt vmcnt(6)
s_xor_b32 s48, s47, 0x52000
buffer_load_dwordx4 v[96:99], v2, s[16:19], s48 offen offset:0 nt
v_mfma_f32_16x16x32_bf16 v[16:19], v[24:27], v[68:71], v[16:19]
v_sub_f32 v28, v156, v9
v_sub_f32 v29, v157, v9
v_mul_f32 v28, s49, v28
v_mul_f32 v29, s49, v29
v_exp_f32 v28, v28
v_exp_f32 v29, v29
v_cvt_pk_bf16_f32 v156, v28, v28
v_add_f32 v8, v8, v28
v_cvt_pk_bf16_f32 v157, v29, v29
v_add_f32 v8, v8, v29
s_cmp_gt_u32 s54, 14
s_cbranch_scc1 L_b171
s_waitcnt vmcnt(4)
L_b171:
s_waitcnt vmcnt(6)
buffer_load_dwordx4 v[100:103], v2, s[16:19], s48 offen offset:256 nt
v_mfma_f32_16x16x32_bf16 v[12:15], v[20:23], v[72:75], v[12:15]
v_and_b32 v24, v139, v4
v_and_b32 v25, v139, v5
v_and_b32 v26, v139, v6
v_and_b32 v27, v139, v7
s_cmp_gt_u32 s54, 15
s_cbranch_scc1 L_b172
s_waitcnt vmcnt(4)
L_b172:
s_waitcnt vmcnt(6)
s_xor_b32 s48, s47, 0x54000
buffer_load_dwordx4 v[104:107], v2, s[16:19], s48 offen offset:0 nt
v_mfma_f32_16x16x32_bf16 v[16:19], v[20:23], v[76:79], v[16:19]
v_sub_f32 v28, v158, v9
v_sub_f32 v29, v159, v9
v_mul_f32 v28, s49, v28
v_mul_f32 v29, s49, v29
v_exp_f32 v28, v28
v_exp_f32 v29, v29
v_cvt_pk_bf16_f32 v158, v28, v28
v_add_f32 v8, v8, v28
v_cvt_pk_bf16_f32 v159, v29, v29
v_add_f32 v8, v8, v29
s_cmp_gt_u32 s54, 16
s_cbranch_scc1 L_b173
s_waitcnt vmcnt(4)
L_b173:
s_waitcnt vmcnt(6)
buffer_load_dwordx4 v[108:111], v2, s[16:19], s48 offen offset:256 nt
v_mfma_f32_16x16x32_bf16 v[12:15], v[24:27], v[80:83], v[12:15]
v_and_b32 v20, v140, v4
v_and_b32 v21, v140, v5
v_and_b32 v22, v140, v6
v_and_b32 v23, v140, v7
s_cmp_gt_u32 s54, 17
s_cbranch_scc1 L_b174
s_waitcnt vmcnt(4)
L_b174:
s_waitcnt vmcnt(6)
s_xor_b32 s48, s47, 0x56000
buffer_load_dwordx4 v[112:115], v2, s[16:19], s48 offen offset:0 nt
v_mfma_f32_16x16x32_bf16 v[16:19], v[24:27], v[84:87], v[16:19]
v_sub_f32 v28, v160, v9
v_sub_f32 v29, v161, v9
v_mul_f32 v28, s49, v28
v_mul_f32 v29, s49, v29
v_exp_f32 v28, v28
v_exp_f32 v29, v29
v_cvt_pk_bf16_f32 v160, v28, v28
v_add_f32 v8, v8, v28
v_cvt_pk_bf16_f32 v161, v29, v29
v_add_f32 v8, v8, v29
s_cmp_gt_u32 s54, 18
s_cbranch_scc1 L_b175
s_waitcnt vmcnt(4)
L_b175:
s_waitcnt vmcnt(6)
buffer_load_dwordx4 v[116:119], v2, s[16:19], s48 offen offset:256 nt
v_mfma_f32_16x16x32_bf16 v[12:15], v[20:23], v[88:91], v[12:15]
v_and_b32 v24, v141, v4
v_and_b32 v25, v141, v5
v_and_b32 v26, v141, v6
v_and_b32 v27, v141, v7
s_cmp_gt_u32 s54, 19
s_cbranch_scc1 L_b176
s_waitcnt vmcnt(4)
L_b176:
s_waitcnt vmcnt(6)
s_xor_b32 s48, s47, 0x60000
buffer_load_dwordx4 v[56:59], v2, s[16:19], s48 offen offset:0 nt
v_mfma_f32_16x16x32_bf16 v[16:19], v[20:23], v[92:95], v[16:19]
v_sub_f32 v28, v162, v9
v_sub_f32 v29, v163, v9
v_mul_f32 v28, s49, v28
v_mul_f32 v29, s49, v29
v_exp_f32 v28, v28
v_exp_f32 v29, v29
v_cvt_pk_bf16_f32 v162, v28, v28
v_add_f32 v8, v8, v28
v_cvt_pk_bf16_f32 v163, v29, v29
v_add_f32 v8, v8, v29
s_cmp_gt_u32 s54, 20
s_cbranch_scc1 L_b177
s_waitcnt vmcnt(4)
L_b177:
s_waitcnt vmcnt(6)
buffer_load_dwordx4 v[60:63], v2, s[16:19], s48 offen offset:256 nt
v_mfma_f32_16x16x32_bf16 v[12:15], v[24:27], v[96:99], v[12:15]
v_and_b32 v20, v142, v4
v_and_b32 v21, v142, v5
v_and_b32 v22, v142, v6
v_and_b32 v23, v142, v7
s_cmp_gt_u32 s54, 21
s_cbranch_scc1 L_b178
s_waitcnt vmcnt(4)
L_b178:
s_waitcnt vmcnt(6)
s_xor_b32 s48, s47, 0x62000
buffer_load_dwordx4 v[64:67], v2, s[16:19], s48 offen offset:0 nt
v_mfma_f32_16x16x32_bf16 v[16:19], v[24:27], v[100:103], v[16:19]
v_sub_f32 v28, v164, v9
v_sub_f32 v29, v165, v9
v_mul_f32 v28, s49, v28
v_mul_f32 v29, s49, v29
v_exp_f32 v28, v28
v_exp_f32 v29, v29
v_cvt_pk_bf16_f32 v164, v28, v28
v_add_f32 v8, v8, v28
v_cvt_pk_bf16_f32 v165, v29, v29
v_add_f32 v8, v8, v29
s_cmp_gt_u32 s54, 22
s_cbranch_scc1 L_b179
s_waitcnt vmcnt(4)
L_b179:
s_waitcnt vmcnt(6)
buffer_load_dwordx4 v[68:71], v2, s[16:19], s48 offen offset:256 nt
v_mfma_f32_16x16x32_bf16 v[12:15], v[20:23], v[104:107], v[12:15]
v_and_b32 v24, v143, v4
v_and_b32 v25, v143, v5
v_and_b32 v26, v143, v6
v_and_b32 v27, v143, v7
s_cmp_gt_u32 s54, 23
s_cbranch_scc1 L_b180
s_waitcnt vmcnt(4)
L_b180:
s_waitcnt vmcnt(6)
s_xor_b32 s48, s47, 0x64000
buffer_load_dwordx4 v[72:75], v2, s[16:19], s48 offen offset:0 nt
v_mfma_f32_16x16x32_bf16 v[16:19], v[20:23], v[108:111], v[16:19]
v_sub_f32 v28, v166, v9
v_sub_f32 v29, v167, v9
v_mul_f32 v28, s49, v28
v_mul_f32 v29, s49, v29
v_exp_f32 v28, v28
v_exp_f32 v29, v29
v_cvt_pk_bf16_f32 v166, v28, v28
v_add_f32 v8, v8, v28
v_cvt_pk_bf16_f32 v167, v29, v29
v_add_f32 v8, v8, v29
s_cmp_gt_u32 s54, 24
s_cbranch_scc1 L_b181
s_waitcnt vmcnt(4)
L_b181:
s_waitcnt vmcnt(6)
buffer_load_dwordx4 v[76:79], v2, s[16:19], s48 offen offset:256 nt
v_mfma_f32_16x16x32_bf16 v[12:15], v[24:27], v[112:115], v[12:15]
v_and_b32 v20, v144, v4
v_and_b32 v21, v144, v5
v_and_b32 v22, v144, v6
v_and_b32 v23, v144, v7
s_cmp_gt_u32 s54, 25
s_cbranch_scc1 L_b182
s_waitcnt vmcnt(4)
L_b182:
s_waitcnt vmcnt(6)
s_xor_b32 s48, s47, 0x66000
buffer_load_dwordx4 v[80:83], v2, s[16:19], s48 offen offset:0 nt
v_mfma_f32_16x16x32_bf16 v[16:19], v[24:27], v[116:119], v[16:19]
v_sub_f32 v28, v168, v9
v_sub_f32 v29, v169, v9
v_mul_f32 v28, s49, v28
v_mul_f32 v29, s49, v29
v_exp_f32 v28, v28
v_exp_f32 v29, v29
v_cvt_pk_bf16_f32 v168, v28, v28
v_add_f32 v8, v8, v28
v_cvt_pk_bf16_f32 v169, v29, v29
v_add_f32 v8, v8, v29
s_waitcnt vmcnt(4)
buffer_load_dwordx4 v[84:87], v2, s[16:19], s48 offen offset:256 nt
v_mfma_f32_16x16x32_bf16 v[12:15], v[20:23], v[56:59], v[12:15]
v_and_b32 v24, v145, v4
v_and_b32 v25, v145, v5
v_and_b32 v26, v145, v6
v_and_b32 v27, v145, v7
s_waitcnt vmcnt(4)
s_xor_b32 s48, s47, 0x70000
buffer_load_dwordx4 v[88:91], v2, s[16:19], s48 offen offset:0 nt
v_mfma_f32_16x16x32_bf16 v[16:19], v[20:23], v[60:63], v[16:19]
v_sub_f32 v28, v170, v9
v_sub_f32 v29, v171, v9
v_mul_f32 v28, s49, v28
v_mul_f32 v29, s49, v29
v_exp_f32 v28, v28
v_exp_f32 v29, v29
v_cvt_pk_bf16_f32 v170, v28, v28
v_add_f32 v8, v8, v28
v_cvt_pk_bf16_f32 v171, v29, v29
v_add_f32 v8, v8, v29
s_waitcnt vmcnt(4)
buffer_load_dwordx4 v[92:95], v2, s[16:19], s48 offen offset:256 nt
v_mfma_f32_16x16x32_bf16 v[12:15], v[24:27], v[64:67], v[12:15]
v_and_b32 v20, v146, v4
v_and_b32 v21, v146, v5
v_and_b32 v22, v146, v6
v_and_b32 v23, v146, v7
s_waitcnt vmcnt(4)
s_xor_b32 s48, s47, 0x72000
buffer_load_dwordx4 v[96:99], v2, s[16:19], s48 offen offset:0 nt
v_mfma_f32_16x16x32_bf16 v[16:19], v[24:27], v[68:71], v[16:19]
v_sub_f32 v28, v172, v9
v_sub_f32 v29, v173, v9
v_mul_f32 v28, s49, v28
v_mul_f32 v29, s49, v29
v_exp_f32 v28, v28
v_exp_f32 v29, v29
v_cvt_pk_bf16_f32 v172, v28, v28
v_add_f32 v8, v8, v28
v_cvt_pk_bf16_f32 v173, v29, v29
v_add_f32 v8, v8, v29
s_waitcnt vmcnt(4)
buffer_load_dwordx4 v[100:103], v2, s[16:19], s48 offen offset:256 nt
v_mfma_f32_16x16x32_bf16 v[12:15], v[20:23], v[72:75], v[12:15]
v_and_b32 v24, v147, v4
v_and_b32 v25, v147, v5
v_and_b32 v26, v147, v6
v_and_b32 v27, v147, v7
s_waitcnt vmcnt(4)
s_xor_b32 s48, s47, 0x74000
buffer_load_dwordx4 v[104:107], v2, s[16:19], s48 offen offset:0 nt
v_mfma_f32_16x16x32_bf16 v[16:19], v[20:23], v[76:79], v[16:19]
v_sub_f32 v28, v174, v9
v_sub_f32 v29, v175, v9
v_mul_f32 v28, s49, v28
v_mul_f32 v29, s49, v29
v_exp_f32 v28, v28
v_exp_f32 v29, v29
v_cvt_pk_bf16_f32 v174, v28, v28
v_add_f32 v8, v8, v28
v_cvt_pk_bf16_f32 v175, v29, v29
v_add_f32 v8, v8, v29
s_waitcnt vmcnt(4)
buffer_load_dwordx4 v[108:111], v2, s[16:19], s48 offen offset:256 nt
v_mfma_f32_16x16x32_bf16 v[12:15], v[24:27], v[80:83], v[12:15]
v_and_b32 v20, v148, v4
v_and_b32 v21, v148, v5
v_and_b32 v22, v148, v6
v_and_b32 v23, v148, v7
s_waitcnt vmcnt(4)
s_xor_b32 s48, s47, 0x76000
buffer_load_dwordx4 v[112:115], v2, s[16:19], s48 offen offset:0 nt
v_mfma_f32_16x16x32_bf16 v[16:19], v[24:27], v[84:87], v[16:19]
v_sub_f32 v28, v176, v9
v_sub_f32 v29, v177, v9
v_mul_f32 v28, s49, v28
v_mul_f32 v29, s49, v29
v_exp_f32 v28, v28
v_exp_f32 v29, v29
v_cvt_pk_bf16_f32 v176, v28, v28
v_add_f32 v8, v8, v28
v_cvt_pk_bf16_f32 v177, v29, v29
v_add_f32 v8, v8, v29
s_waitcnt vmcnt(4)
buffer_load_dwordx4 v[116:119], v2, s[16:19], s48 offen offset:256 nt
v_mfma_f32_16x16x32_bf16 v[12:15], v[20:23], v[88:91], v[12:15]
v_and_b32 v24, v149, v4
v_and_b32 v25, v149, v5
v_and_b32 v26, v149, v6
v_and_b32 v27, v149, v7
s_waitcnt vmcnt(4)
s_xor_b32 s48, s47, 0x100000
buffer_load_dwordx4 v[56:59], v2, s[16:19], s48 offen offset:0 nt
v_mfma_f32_16x16x32_bf16 v[16:19], v[20:23], v[92:95], v[16:19]
v_sub_f32 v28, v178, v9
v_sub_f32 v29, v179, v9
v_mul_f32 v28, s49, v28
v_mul_f32 v29, s49, v29
v_exp_f32 v28, v28
v_exp_f32 v29, v29
v_cvt_pk_bf16_f32 v178, v28, v28
v_add_f32 v8, v8, v28
v_cvt_pk_bf16_f32 v179, v29, v29
v_add_f32 v8, v8, v29
s_waitcnt vmcnt(4)
buffer_load_dwordx4 v[60:63], v2, s[16:19], s48 offen offset:256 nt
v_mfma_f32_16x16x32_bf16 v[12:15], v[24:27], v[96:99], v[12:15]
v_and_b32 v20, v150, v4
v_and_b32 v21, v150, v5
v_and_b32 v22, v150, v6
v_and_b32 v23, v150, v7
s_waitcnt vmcnt(4)
s_xor_b32 s48, s47, 0x102000
buffer_load_dwordx4 v[64:67], v2, s[16:19], s48 offen offset:0 nt
v_mfma_f32_16x16x32_bf16 v[16:19], v[24:27], v[100:103], v[16:19]
v_sub_f32 v28, v180, v9
v_sub_f32 v29, v181, v9
v_mul_f32 v28, s49, v28
v_mul_f32 v29, s49, v29
v_exp_f32 v28, v28
v_exp_f32 v29, v29
v_cvt_pk_bf16_f32 v180, v28, v28
v_add_f32 v8, v8, v28
v_cvt_pk_bf16_f32 v181, v29, v29
v_add_f32 v8, v8, v29
s_waitcnt vmcnt(4)
buffer_load_dwordx4 v[68:71], v2, s[16:19], s48 offen offset:256 nt
v_mfma_f32_16x16x32_bf16 v[12:15], v[20:23], v[104:107], v[12:15]
v_and_b32 v24, v151, v4
v_and_b32 v25, v151, v5
v_and_b32 v26, v151, v6
v_and_b32 v27, v151, v7
s_waitcnt vmcnt(4)
s_xor_b32 s48, s47, 0x104000
buffer_load_dwordx4 v[72:75], v2, s[16:19], s48 offen offset:0 nt
v_mfma_f32_16x16x32_bf16 v[16:19], v[20:23], v[108:111], v[16:19]
v_sub_f32 v28, v182, v9
v_sub_f32 v29, v183, v9
v_mul_f32 v28, s49, v28
v_mul_f32 v29, s49, v29
v_exp_f32 v28, v28
v_exp_f32 v29, v29
v_cvt_pk_bf16_f32 v182, v28, v28
v_add_f32 v8, v8, v28
v_cvt_pk_bf16_f32 v183, v29, v29
v_add_f32 v8, v8, v29
s_waitcnt vmcnt(4)
buffer_load_dwordx4 v[76:79], v2, s[16:19], s48 offen offset:256 nt
v_mfma_f32_16x16x32_bf16 v[12:15], v[24:27], v[112:115], v[12:15]
v_and_b32 v20, v152, v4
v_and_b32 v21, v152, v5
v_and_b32 v22, v152, v6
v_and_b32 v23, v152, v7
s_waitcnt vmcnt(4)
s_xor_b32 s48, s47, 0x106000
buffer_load_dwordx4 v[80:83], v2, s[16:19], s48 offen offset:0 nt
v_mfma_f32_16x16x32_bf16 v[16:19], v[24:27], v[116:119], v[16:19]
v_mov_b32 v28, v8
s_nop 1
v_permlane32_swap_b32 v8, v28
s_nop 1
v_add_f32 v8, v8, v28
v_mov_b32 v28, v8
s_nop 1
v_permlane16_swap_b32 v8, v28
s_nop 1
v_add_f32 v8, v8, v28
ds_write2_b32 v11, v9, v8 offset0:0 offset1:1
s_waitcnt vmcnt(4)
buffer_load_dwordx4 v[84:87], v2, s[16:19], s48 offen offset:256 nt
v_mfma_f32_16x16x32_bf16 v[12:15], v[20:23], v[56:59], v[12:15]
v_and_b32 v24, v153, v4
v_and_b32 v25, v153, v5
v_and_b32 v26, v153, v6
v_and_b32 v27, v153, v7
s_waitcnt vmcnt(4)
s_xor_b32 s48, s47, 0x110000
buffer_load_dwordx4 v[88:91], v2, s[16:19], s48 offen offset:0 nt
v_mfma_f32_16x16x32_bf16 v[16:19], v[20:23], v[60:63], v[16:19]
s_waitcnt vmcnt(4)
buffer_load_dwordx4 v[92:95], v2, s[16:19], s48 offen offset:256 nt
v_mfma_f32_16x16x32_bf16 v[12:15], v[24:27], v[64:67], v[12:15]
v_and_b32 v20, v154, v4
v_and_b32 v21, v154, v5
v_and_b32 v22, v154, v6
v_and_b32 v23, v154, v7
s_waitcnt vmcnt(4)
s_xor_b32 s48, s47, 0x112000
buffer_load_dwordx4 v[96:99], v2, s[16:19], s48 offen offset:0 nt
v_mfma_f32_16x16x32_bf16 v[16:19], v[24:27], v[68:71], v[16:19]
s_waitcnt vmcnt(4)
buffer_load_dwordx4 v[100:103], v2, s[16:19], s48 offen offset:256 nt
v_mfma_f32_16x16x32_bf16 v[12:15], v[20:23], v[72:75], v[12:15]
v_and_b32 v24, v155, v4
v_and_b32 v25, v155, v5
v_and_b32 v26, v155, v6
v_and_b32 v27, v155, v7
s_waitcnt vmcnt(4)
s_xor_b32 s48, s47, 0x114000
buffer_load_dwordx4 v[104:107], v2, s[16:19], s48 offen offset:0 nt
buffer_load_ushort v30, v184, s[28:31], s50 offen offset:256 nt
buffer_store_byte v186, v185, s[28:31], s50 offen offset:256
v_mfma_f32_16x16x32_bf16 v[16:19], v[20:23], v[76:79], v[16:19]
s_waitcnt vmcnt(6)
buffer_load_dwordx4 v[108:111], v2, s[16:19], s48 offen offset:256 nt
v_mfma_f32_16x16x32_bf16 v[12:15], v[24:27], v[80:83], v[12:15]
v_and_b32 v20, v156, v4
v_and_b32 v21, v156, v5
v_and_b32 v22, v156, v6
v_and_b32 v23, v156, v7
s_waitcnt vmcnt(6)
s_xor_b32 s48, s47, 0x116000
buffer_load_dwordx4 v[112:115], v2, s[16:19], s48 offen offset:0 nt
v_mfma_f32_16x16x32_bf16 v[16:19], v[24:27], v[84:87], v[16:19]
s_waitcnt vmcnt(6)
buffer_load_dwordx4 v[116:119], v2, s[16:19], s48 offen offset:256 nt
v_mfma_f32_16x16x32_bf16 v[12:15], v[20:23], v[88:91], v[12:15]
v_and_b32 v24, v157, v4
v_and_b32 v25, v157, v5
v_and_b32 v26, v157, v6
v_and_b32 v27, v157, v7
s_waitcnt vmcnt(6)
s_xor_b32 s48, s47, 0x120000
buffer_load_dwordx4 v[56:59], v2, s[16:19], s48 offen offset:0 nt
v_mfma_f32_16x16x32_bf16 v[16:19], v[20:23], v[92:95], v[16:19]
s_waitcnt vmcnt(6)
buffer_load_dwordx4 v[60:63], v2, s[16:19], s48 offen offset:256 nt
v_mfma_f32_16x16x32_bf16 v[12:15], v[24:27], v[96:99], v[12:15]
v_and_b32 v20, v158, v4
v_and_b32 v21, v158, v5
v_and_b32 v22, v158, v6
v_and_b32 v23, v158, v7
s_waitcnt vmcnt(4)
s_xor_b32 s48, s47, 0x122000
buffer_load_dwordx4 v[64:67], v2, s[16:19], s48 offen offset:0 nt
v_cmp_lt_u32 vcc, 0xff, v30
v_and_b32 v30, 0xff, v30
s_bcnt1_i32_b64 s54, vcc
v_cmp_ne_u32 vcc, 0, v30
s_nop 1
s_bcnt1_i32_b64 s55, vcc
s_add_u32 s54, s54, s55
s_sub_i32 s55, s54, 112
s_max_i32 s55, s55, 0
s_mul_i32 s55, s55, 10
s_sub_i32 s54, s54, 64
s_max_i32 s54, s54, 0
s_mul_i32 s54, s54, 6
s_add_u32 s54, s54, s55
s_lshr_b32 s54, s54, 4
v_mfma_f32_16x16x32_bf16 v[16:19], v[24:27], v[100:103], v[16:19]
s_cmp_gt_u32 s54, 0
s_cbranch_scc1 L_b211
s_waitcnt vmcnt(4)
L_b211:
buffer_load_dwordx4 v[68:71], v2, s[16:19], s48 offen offset:256 nt
v_mfma_f32_16x16x32_bf16 v[12:15], v[20:23], v[104:107], v[12:15]
v_and_b32 v24, v159, v4
v_and_b32 v25, v159, v5
v_and_b32 v26, v159, v6
v_and_b32 v27, v159, v7
s_cmp_gt_u32 s54, 1
s_cbranch_scc1 L_b212
s_waitcnt vmcnt(4)
L_b212:
s_xor_b32 s48, s47, 0x124000
buffer_load_dwordx4 v[72:75], v2, s[16:19], s48 offen offset:0 nt
v_mfma_f32_16x16x32_bf16 v[16:19], v[20:23], v[108:111], v[16:19]
s_cmp_gt_u32 s54, 2
s_cbranch_scc1 L_b213
s_waitcnt vmcnt(4)
L_b213:
s_waitcnt vmcnt(6)
buffer_load_dwordx4 v[76:79], v2, s[16:19], s48 offen offset:256 nt
v_mfma_f32_16x16x32_bf16 v[12:15], v[24:27], v[112:115], v[12:15]
v_and_b32 v20, v160, v4
v_and_b32 v21, v160, v5
v_and_b32 v22, v160, v6
v_and_b32 v23, v160, v7
s_cmp_gt_u32 s54, 3
s_cbranch_scc1 L_b214
s_waitcnt vmcnt(4)
L_b214:
s_waitcnt vmcnt(6)
s_xor_b32 s48, s47, 0x126000
buffer_load_dwordx4 v[80:83], v2, s[16:19], s48 offen offset:0 nt
v_mfma_f32_16x16x32_bf16 v[16:19], v[24:27], v[116:119], v[16:19]
s_cmp_gt_u32 s54, 4
s_cbranch_scc1 L_b215
s_waitcnt vmcnt(4)
L_b215:
s_waitcnt vmcnt(6)
buffer_load_dwordx4 v[84:87], v2, s[16:19], s48 offen offset:256 nt
v_mfma_f32_16x16x32_bf16 v[12:15], v[20:23], v[56:59], v[12:15]
v_and_b32 v24, v161, v4
v_and_b32 v25, v161, v5
v_and_b32 v26, v161, v6
v_and_b32 v27, v161, v7
s_cmp_gt_u32 s54, 5
s_cbranch_scc1 L_b216
s_waitcnt vmcnt(4)
L_b216:
s_waitcnt vmcnt(6)
s_xor_b32 s48, s47, 0x130000
buffer_load_dwordx4 v[88:91], v2, s[16:19], s48 offen offset:0 nt
v_mfma_f32_16x16x32_bf16 v[16:19], v[20:23], v[60:63], v[16:19]
v_and_b32 v120, v178, v4
v_and_b32 v121, v178, v5
v_and_b32 v122, v178, v6
v_and_b32 v123, v178, v7
s_cmp_gt_u32 s54, 6
s_cbranch_scc1 L_b217
s_waitcnt vmcnt(4)
L_b217:
s_waitcnt vmcnt(6)
buffer_load_dwordx4 v[92:95], v2, s[16:19], s48 offen offset:256 nt
v_mfma_f32_16x16x32_bf16 v[12:15], v[24:27], v[64:67], v[12:15]
v_and_b32 v20, v162, v4
v_and_b32 v21, v162, v5
v_and_b32 v22, v162, v6
v_and_b32 v23, v162, v7
s_cmp_gt_u32 s54, 7
s_cbranch_scc1 L_b218
s_waitcnt vmcnt(4)
L_b218:
s_waitcnt vmcnt(6)
s_xor_b32 s48, s47, 0x132000
buffer_load_dwordx4 v[96:99], v2, s[16:19], s48 offen offset:0 nt
v_mfma_f32_16x16x32_bf16 v[16:19], v[24:27], v[68:71], v[16:19]
v_and_b32 v124, v179, v4
v_and_b32 v125, v179, v5
v_and_b32 v126, v179, v6
v_and_b32 v127, v179, v7
s_cmp_gt_u32 s54, 8
s_cbranch_scc1 L_b219
s_waitcnt vmcnt(4)
L_b219:
s_waitcnt vmcnt(6)
buffer_load_dwordx4 v[100:103], v2, s[16:19], s48 offen offset:256 nt
v_mfma_f32_16x16x32_bf16 v[12:15], v[20:23], v[72:75], v[12:15]
v_and_b32 v24, v163, v4
v_and_b32 v25, v163, v5
v_and_b32 v26, v163, v6
v_and_b32 v27, v163, v7
s_cmp_gt_u32 s54, 9
s_cbranch_scc1 L_b220
s_waitcnt vmcnt(4)
L_b220:
s_waitcnt vmcnt(6)
s_xor_b32 s48, s47, 0x134000
buffer_load_dwordx4 v[104:107], v2, s[16:19], s48 offen offset:0 nt
v_mfma_f32_16x16x32_bf16 v[16:19], v[20:23], v[76:79], v[16:19]
v_and_b32 v128, v180, v4
v_and_b32 v129, v180, v5
v_and_b32 v130, v180, v6
v_and_b32 v131, v180, v7
s_cmp_gt_u32 s54, 10
s_cbranch_scc1 L_b221
s_waitcnt vmcnt(4)
L_b221:
s_waitcnt vmcnt(6)
buffer_load_dwordx4 v[108:111], v2, s[16:19], s48 offen offset:256 nt
v_mfma_f32_16x16x32_bf16 v[12:15], v[24:27], v[80:83], v[12:15]
v_and_b32 v20, v164, v4
v_and_b32 v21, v164, v5
v_and_b32 v22, v164, v6
v_and_b32 v23, v164, v7
s_cmp_gt_u32 s54, 11
s_cbranch_scc1 L_b222
s_waitcnt vmcnt(4)
L_b222:
s_waitcnt vmcnt(6)
s_xor_b32 s48, s47, 0x136000
buffer_load_dwordx4 v[112:115], v2, s[16:19], s48 offen offset:0 nt
v_mfma_f32_16x16x32_bf16 v[16:19], v[24:27], v[84:87], v[16:19]
v_and_b32 v132, v181, v4
v_and_b32 v133, v181, v5
v_and_b32 v134, v181, v6
v_and_b32 v135, v181, v7
s_cmp_gt_u32 s54, 12
s_cbranch_scc1 L_b223
s_waitcnt vmcnt(4)
L_b223:
s_waitcnt vmcnt(6)
buffer_load_dwordx4 v[116:119], v2, s[16:19], s48 offen offset:256 nt
v_mfma_f32_16x16x32_bf16 v[12:15], v[20:23], v[88:91], v[12:15]
v_and_b32 v24, v165, v4
v_and_b32 v25, v165, v5
v_and_b32 v26, v165, v6
v_and_b32 v27, v165, v7
s_cmp_gt_u32 s54, 13
s_cbranch_scc1 L_b224
s_waitcnt vmcnt(4)
L_b224:
s_waitcnt vmcnt(6)
s_xor_b32 s48, s47, 0x140000
buffer_load_dwordx4 v[56:59], v2, s[16:19], s48 offen offset:0 nt
v_mfma_f32_16x16x32_bf16 v[16:19], v[20:23], v[92:95], v[16:19]
v_and_b32 v136, v182, v4
v_and_b32 v137, v182, v5
v_and_b32 v138, v182, v6
v_and_b32 v139, v182, v7
s_cmp_gt_u32 s54, 14
s_cbranch_scc1 L_b225
s_waitcnt vmcnt(4)
L_b225:
s_waitcnt vmcnt(6)
buffer_load_dwordx4 v[60:63], v2, s[16:19], s48 offen offset:256 nt
v_mfma_f32_16x16x32_bf16 v[12:15], v[24:27], v[96:99], v[12:15]
v_and_b32 v20, v166, v4
v_and_b32 v21, v166, v5
v_and_b32 v22, v166, v6
v_and_b32 v23, v166, v7
s_cmp_gt_u32 s54, 15
s_cbranch_scc1 L_b226
s_waitcnt vmcnt(4)
L_b226:
s_waitcnt vmcnt(6)
s_xor_b32 s48, s47, 0x142000
buffer_load_dwordx4 v[64:67], v2, s[16:19], s48 offen offset:0 nt
v_mfma_f32_16x16x32_bf16 v[16:19], v[24:27], v[100:103], v[16:19]
v_and_b32 v140, v183, v4
v_and_b32 v141, v183, v5
v_and_b32 v142, v183, v6
v_and_b32 v143, v183, v7
s_cmp_gt_u32 s54, 16
s_cbranch_scc1 L_b227
s_waitcnt vmcnt(4)
L_b227:
s_waitcnt vmcnt(6)
buffer_load_dwordx4 v[68:71], v2, s[16:19], s48 offen offset:256 nt
v_mfma_f32_16x16x32_bf16 v[12:15], v[20:23], v[104:107], v[12:15]
v_and_b32 v24, v167, v4
v_and_b32 v25, v167, v5
v_and_b32 v26, v167, v6
v_and_b32 v27, v167, v7
s_cmp_gt_u32 s54, 17
s_cbranch_scc1 L_b228
s_waitcnt vmcnt(4)
L_b228:
s_waitcnt vmcnt(6)
s_xor_b32 s48, s47, 0x144000
buffer_load_dwordx4 v[72:75], v2, s[16:19], s48 offen offset:0 nt
v_mfma_f32_16x16x32_bf16 v[16:19], v[20:23], v[108:111], v[16:19]
s_cmp_gt_u32 s54, 18
s_cbranch_scc1 L_b229
s_waitcnt vmcnt(4)
L_b229:
s_waitcnt vmcnt(6)
buffer_load_dwordx4 v[76:79], v2, s[16:19], s48 offen offset:256 nt
v_mfma_f32_16x16x32_bf16 v[12:15], v[24:27], v[112:115], v[12:15]
v_and_b32 v20, v168, v4
v_and_b32 v21, v168, v5
v_and_b32 v22, v168, v6
v_and_b32 v23, v168, v7
s_cmp_gt_u32 s54, 19
s_cbranch_scc1 L_b230
s_waitcnt vmcnt(4)
L_b230:
s_waitcnt vmcnt(6)
s_xor_b32 s48, s47, 0x146000
buffer_load_dwordx4 v[80:83], v2, s[16:19], s48 offen offset:0 nt
v_mfma_f32_16x16x32_bf16 v[16:19], v[24:27], v[116:119], v[16:19]
s_cmp_gt_u32 s54, 20
s_cbranch_scc1 L_b231
s_waitcnt vmcnt(4)
L_b231:
s_waitcnt vmcnt(6)
buffer_load_dwordx4 v[84:87], v2, s[16:19], s48 offen offset:256 nt
v_mfma_f32_16x16x32_bf16 v[12:15], v[20:23], v[56:59], v[12:15]
v_and_b32 v24, v169, v4
v_and_b32 v25, v169, v5
v_and_b32 v26, v169, v6
v_and_b32 v27, v169, v7
s_cmp_gt_u32 s54, 21
s_cbranch_scc1 L_b232
s_waitcnt vmcnt(4)
L_b232:
s_waitcnt vmcnt(6)
s_xor_b32 s48, s47, 0x150000
buffer_load_dwordx4 v[88:91], v2, s[16:19], s48 offen offset:0 nt
v_mfma_f32_16x16x32_bf16 v[16:19], v[20:23], v[60:63], v[16:19]
s_cmp_gt_u32 s54, 22
s_cbranch_scc1 L_b233
s_waitcnt vmcnt(4)
L_b233:
s_waitcnt vmcnt(6)
buffer_load_dwordx4 v[92:95], v2, s[16:19], s48 offen offset:256 nt
v_mfma_f32_16x16x32_bf16 v[12:15], v[24:27], v[64:67], v[12:15]
v_and_b32 v20, v170, v4
v_and_b32 v21, v170, v5
v_and_b32 v22, v170, v6
v_and_b32 v23, v170, v7
s_cmp_gt_u32 s54, 23
s_cbranch_scc1 L_b234
s_waitcnt vmcnt(4)
L_b234:
s_waitcnt vmcnt(6)
s_xor_b32 s48, s47, 0x152000
buffer_load_dwordx4 v[96:99], v2, s[16:19], s48 offen offset:0 nt
v_mfma_f32_16x16x32_bf16 v[16:19], v[24:27], v[68:71], v[16:19]
s_cmp_gt_u32 s54, 24
s_cbranch_scc1 L_b235
s_waitcnt vmcnt(4)
L_b235:
s_waitcnt vmcnt(6)
buffer_load_dwordx4 v[100:103], v2, s[16:19], s48 offen offset:256 nt
v_mfma_f32_16x16x32_bf16 v[12:15], v[20:23], v[72:75], v[12:15]
v_and_b32 v24, v171, v4
v_and_b32 v25, v171, v5
v_and_b32 v26, v171, v6
v_and_b32 v27, v171, v7
s_cmp_gt_u32 s54, 25
s_cbranch_scc1 L_b236
s_waitcnt vmcnt(4)
L_b236:
s_waitcnt vmcnt(6)
s_xor_b32 s48, s47, 0x154000
buffer_load_dwordx4 v[104:107], v2, s[16:19], s48 offen offset:0 nt
v_mfma_f32_16x16x32_bf16 v[16:19], v[20:23], v[76:79], v[16:19]
s_cmp_gt_u32 s54, 26
s_cbranch_scc1 L_b237
s_waitcnt vmcnt(4)
L_b237:
s_waitcnt vmcnt(6)
buffer_load_dwordx4 v[108:111], v2, s[16:19], s48 offen offset:256 nt
v_mfma_f32_16x16x32_bf16 v[12:15], v[24:27], v[80:83], v[12:15]
v_and_b32 v20, v172, v4
v_and_b32 v21, v172, v5
v_and_b32 v22, v172, v6
v_and_b32 v23, v172, v7
s_cmp_gt_u32 s54, 27
s_cbranch_scc1 L_b238
s_waitcnt vmcnt(4)
L_b238:
s_waitcnt vmcnt(6)
s_xor_b32 s48, s47, 0x156000
buffer_load_dwordx4 v[112:115], v2, s[16:19], s48 offen offset:0 nt
v_mfma_f32_16x16x32_bf16 v[16:19], v[24:27], v[84:87], v[16:19]
s_cmp_gt_u32 s54, 28
s_cbranch_scc1 L_b239
s_waitcnt vmcnt(4)
L_b239:
s_waitcnt vmcnt(6)
buffer_load_dwordx4 v[116:119], v2, s[16:19], s48 offen offset:256 nt
v_mfma_f32_16x16x32_bf16 v[12:15], v[20:23], v[88:91], v[12:15]
v_and_b32 v24, v173, v4
v_and_b32 v25, v173, v5
v_and_b32 v26, v173, v6
v_and_b32 v27, v173, v7
s_cmp_gt_u32 s54, 29
s_cbranch_scc1 L_b240
s_waitcnt vmcnt(4)
L_b240:
s_waitcnt vmcnt(6)
s_xor_b32 s48, s47, 0x160000
buffer_load_dwordx4 v[56:59], v2, s[16:19], s48 offen offset:0 nt
v_mfma_f32_16x16x32_bf16 v[16:19], v[20:23], v[92:95], v[16:19]
s_cmp_gt_u32 s54, 30
s_cbranch_scc1 L_b241
s_waitcnt vmcnt(4)
L_b241:
s_waitcnt vmcnt(6)
buffer_load_dwordx4 v[60:63], v2, s[16:19], s48 offen offset:256 nt
v_mfma_f32_16x16x32_bf16 v[12:15], v[24:27], v[96:99], v[12:15]
v_and_b32 v20, v174, v4
v_and_b32 v21, v174, v5
v_and_b32 v22, v174, v6
v_and_b32 v23, v174, v7
s_cmp_gt_u32 s54, 31
s_cbranch_scc1 L_b242
s_waitcnt vmcnt(4)
L_b242:
s_waitcnt vmcnt(6)
s_xor_b32 s48, s47, 0x162000
buffer_load_dwordx4 v[64:67], v2, s[16:19], s48 offen offset:0 nt
v_mfma_f32_16x16x32_bf16 v[16:19], v[24:27], v[100:103], v[16:19]
s_cmp_gt_u32 s54, 32
s_cbranch_scc1 L_b243
s_waitcnt vmcnt(4)
L_b243:
s_waitcnt vmcnt(6)
buffer_load_dwordx4 v[68:71], v2, s[16:19], s48 offen offset:256 nt
s_xor_b32 s48, s47, 0x164000
buffer_load_dwordx4 v[72:75], v2, s[16:19], s48 offen offset:0 nt
v_mfma_f32_16x16x32_bf16 v[12:15], v[20:23], v[104:107], v[12:15]
v_and_b32 v24, v175, v4
v_and_b32 v25, v175, v5
v_and_b32 v26, v175, v6
v_and_b32 v27, v175, v7
s_waitcnt vmcnt(7)
buffer_load_dwordx4 v[76:79], v2, s[16:19], s48 offen offset:256 nt
v_mfma_f32_16x16x32_bf16 v[16:19], v[20:23], v[108:111], v[16:19]
s_waitcnt vmcnt(7)
s_xor_b32 s48, s47, 0x166000
buffer_load_dwordx4 v[80:83], v2, s[16:19], s48 offen offset:0 nt
v_mfma_f32_16x16x32_bf16 v[12:15], v[24:27], v[112:115], v[12:15]
v_and_b32 v20, v176, v4
v_and_b32 v21, v176, v5
v_and_b32 v22, v176, v6
v_and_b32 v23, v176, v7
s_waitcnt vmcnt(7)
buffer_load_dwordx4 v[84:87], v2, s[16:19], s48 offen offset:256 nt
v_mfma_f32_16x16x32_bf16 v[16:19], v[24:27], v[116:119], v[16:19]
s_waitcnt lgkmcnt(0)
s_barrier
s_waitcnt vmcnt(7)
s_xor_b32 s48, s47, 0x170000
buffer_load_dwordx4 v[88:91], v2, s[16:19], s48 offen offset:0 nt
v_mfma_f32_16x16x32_bf16 v[12:15], v[20:23], v[56:59], v[12:15]
v_and_b32 v24, v177, v4
v_and_b32 v25, v177, v5
v_and_b32 v26, v177, v6
v_and_b32 v27, v177, v7
s_waitcnt vmcnt(7)
buffer_load_dwordx4 v[92:95], v2, s[16:19], s48 offen offset:256 nt
v_mfma_f32_16x16x32_bf16 v[16:19], v[20:23], v[60:63], v[16:19]
s_waitcnt vmcnt(7)
s_xor_b32 s48, s47, 0x172000
buffer_load_dwordx4 v[96:99], v2, s[16:19], s48 offen offset:0 nt
v_mfma_f32_16x16x32_bf16 v[12:15], v[24:27], v[64:67], v[12:15]
s_waitcnt vmcnt(7)
buffer_load_dwordx4 v[100:103], v2, s[16:19], s48 offen offset:256 nt
v_mfma_f32_16x16x32_bf16 v[16:19], v[24:27], v[68:71], v[16:19]
s_waitcnt vmcnt(7)
s_xor_b32 s48, s47, 0x174000
buffer_load_dwordx4 v[104:107], v2, s[16:19], s48 offen offset:0 nt
v_mfma_f32_16x16x32_bf16 v[12:15], v[120:123], v[72:75], v[12:15]
s_waitcnt vmcnt(7)
buffer_load_dwordx4 v[108:111], v2, s[16:19], s48 offen offset:256 nt
v_mfma_f32_16x16x32_bf16 v[16:19], v[120:123], v[76:79], v[16:19]
s_waitcnt vmcnt(7)
s_xor_b32 s48, s47, 0x176000
buffer_load_dwordx4 v[112:115], v2, s[16:19], s48 offen offset:0 nt
v_mfma_f32_16x16x32_bf16 v[12:15], v[124:127], v[80:83], v[12:15]
s_waitcnt vmcnt(7)
buffer_load_dwordx4 v[116:119], v2, s[16:19], s48 offen offset:256 nt
v_mfma_f32_16x16x32_bf16 v[16:19], v[124:127], v[84:87], v[16:19]
s_waitcnt vmcnt(7)
v_mfma_f32_16x16x32_bf16 v[12:15], v[128:131], v[88:91], v[12:15]
s_waitcnt vmcnt(6)
v_mfma_f32_16x16x32_bf16 v[16:19], v[128:131], v[92:95], v[16:19]
s_waitcnt vmcnt(5)
v_mfma_f32_16x16x32_bf16 v[12:15], v[132:135], v[96:99], v[12:15]
s_waitcnt vmcnt(4)
v_mfma_f32_16x16x32_bf16 v[16:19], v[132:135], v[100:103], v[16:19]
s_waitcnt vmcnt(3)
v_mfma_f32_16x16x32_bf16 v[12:15], v[136:139], v[104:107], v[12:15]
s_waitcnt vmcnt(2)
v_mfma_f32_16x16x32_bf16 v[16:19], v[136:139], v[108:111], v[16:19]
s_waitcnt vmcnt(1)
v_mfma_f32_16x16x32_bf16 v[12:15], v[140:143], v[112:115], v[12:15]
s_waitcnt vmcnt(0)
v_mfma_f32_16x16x32_bf16 v[16:19], v[140:143], v[116:119], v[16:19]
s_nop 5
ds_write_b128 v10, v[12:15] offset:128
s_nop 0
ds_write_b128 v10, v[16:19] offset:384
s_waitcnt lgkmcnt(0)
s_barrier
s_endpgm
.p2align 6
L_helper:
s_load_dwordx2 s[28:29], s[0:1], 64
s_load_dwordx2 s[52:53], s[0:1], 56
s_load_dwordx2 s[32:33], s[0:1], 24
s_load_dwordx2 s[36:37], s[0:1], 32
s_load_dwordx2 s[44:45], s[0:1], 40
s_load_dwordx2 s[40:41], s[0:1], 48
v_and_b32 v1, 63, v0
v_lshlrev_b32 v4, 4, v1
v_mov_b32 v12, -1
v_mov_b32 v13, -1
v_mov_b32 v14, -1
v_mov_b32 v15, -1
s_mov_b32 s30, 0x208000
s_mov_b32 s31, 0x20000
s_lshl_b32 s50, s2, 12
s_lshr_b32 s4, s47, 21
s_lshr_b32 s27, s4, 4
s_lshl_b32 s27, s27, 2
s_lshl_b32 s7, s4, 10
s_lshl_b32 s26, s4, 9
v_and_b32 v5, 0x1f0, v4
s_mov_b32 s22, 65536
s_mov_b32 s23, 0x20000
s_mov_b32 s34, 32768
s_mov_b32 s35, 0x20000
s_mov_b32 s38, 32768
s_mov_b32 s39, 0x20000
s_mov_b32 s42, 65536
s_mov_b32 s43, 0x20000
s_getreg_b32 s8, hwreg(HW_REG_XCC_ID, 0, 4)
s_or_b32 s8, s8, 16
s_bfe_u32 s9, s2, 0x10005
s_bfe_u32 s10, s2, 0x10006
s_lshl_b32 s10, s10, 1
s_or_b32 s9, s9, s10
s_mul_i32 s10, s9, 5
s_lshl_b32 s11, s8, s10
s_or_b32 s10, s11, 0x100000
s_mul_i32 s8, s8, 0x8421
s_lshl_b32 s51, s4, 2
v_mov_b32 v8, s51
v_mov_b32 v9, s10
s_waitcnt lgkmcnt(0)
s_load_dword s27, s[44:45], s27
buffer_store_dwordx4 v[12:15], v4, s[28:31], s50 offen
buffer_store_dwordx4 v[12:15], v4, s[28:31], s50 offen offset:1024
s_mov_b64 exec, 0xff
buffer_store_dwordx4 v[12:15], v4, s[28:31], s50 offen offset:2048
s_mov_b64 exec, 7
v_lshlrev_b32 v2, 7, v1
v_mov_b32 v3, 0
s_and_b32 s6, s2, 7
s_lshl_b32 s6, s6, 12
s_add_u32 s6, s6, 0x200000
s_lshr_b32 s51, s2, 3
s_lshl_b32 s51, s51, 2
s_add_u32 s6, s6, s51
buffer_store_dword v3, v2, s[28:31], s6 offen
s_mov_b64 exec, -1
s_mov_b32 s49, 0x3db8aa3b
v_lshrrev_b32 v7, 5, v1
v_lshlrev_b32 v7, 3, v7
v_mov_b32 v6, 0xff800000
v_mov_b32 v32, 0
v_mov_b32 v33, 0
v_mov_b32 v34, 0
v_mov_b32 v35, 0
v_mov_b32 v36, 0
v_mov_b32 v37, 0
v_mov_b32 v38, 0
v_mov_b32 v39, 0
s_cmp_lg_u32 s9, 0
s_cbranch_scc1 L_notree
buffer_load_dwordx4 v[16:19], v4, s[20:23], s7 offen
buffer_load_dwordx4 v[20:23], v5, s[32:35], s26 offen
buffer_load_dwordx4 v[24:27], v5, s[36:39], s26 offen
s_waitcnt vmcnt(0) lgkmcnt(0)
v_mov_b32 v6, 0
v_lshlrev_b32 v28, 16, v16
v_lshlrev_b32 v29, 16, v20
v_fmac_f32 v6, v28, v29
v_and_b32 v28, 0xffff0000, v16
v_and_b32 v29, 0xffff0000, v20
v_fmac_f32 v6, v28, v29
v_lshlrev_b32 v28, 16, v17
v_lshlrev_b32 v29, 16, v21
v_fmac_f32 v6, v28, v29
v_and_b32 v28, 0xffff0000, v17
v_and_b32 v29, 0xffff0000, v21
v_fmac_f32 v6, v28, v29
v_lshlrev_b32 v28, 16, v18
v_lshlrev_b32 v29, 16, v22
v_fmac_f32 v6, v28, v29
v_and_b32 v28, 0xffff0000, v18
v_and_b32 v29, 0xffff0000, v22
v_fmac_f32 v6, v28, v29
v_lshlrev_b32 v28, 16, v19
v_lshlrev_b32 v29, 16, v23
v_fmac_f32 v6, v28, v29
v_and_b32 v28, 0xffff0000, v19
v_and_b32 v29, 0xffff0000, v23
v_fmac_f32 v6, v28, v29
s_nop 1
v_add_f32_dpp v6, v6, v6 row_ror:8 row_mask:0xf bank_mask:0xf
s_nop 1
v_add_f32_dpp v6, v6, v6 row_ror:4 row_mask:0xf bank_mask:0xf
s_nop 1
v_add_f32_dpp v6, v6, v6 row_ror:2 row_mask:0xf bank_mask:0xf
s_nop 1
v_add_f32_dpp v6, v6, v6 row_ror:1 row_mask:0xf bank_mask:0xf
v_mov_b32 v28, v6
s_nop 1
v_permlane16_swap_b32 v6, v28
s_nop 1
v_add_f32 v6, v6, v28
s_bitcmp1_b32 s4, 3
s_cselect_b32 s51, 0, 16
s_lshl_b32 s27, s27, s51
s_and_b32 s27, s27, 0xffff0000
v_mov_b32 v29, s27
v_sub_f32 v29, 1.0, v29
v_mul_f32 v29, 0xd06e6b28, v29
v_add_f32 v6, v6, v29
v_lshlrev_b32 v32, 16, v24
v_and_b32 v33, 0xffff0000, v24
v_lshlrev_b32 v34, 16, v25
v_and_b32 v35, 0xffff0000, v25
v_lshlrev_b32 v36, 16, v26
v_and_b32 v37, 0xffff0000, v26
v_lshlrev_b32 v38, 16, v27
v_and_b32 v39, 0xffff0000, v27
L_notree:
s_mov_b32 s56, -2
s_xor_b32 s57, s50, 0x20000
s_xor_b32 s58, s50, 0x40000
s_xor_b32 s59, s50, 0x60000
s_mov_b32 s5, 0x100000
s_waitcnt vmcnt(0) lgkmcnt(0)
s_lshl_b32 s6, s4, 2
s_barrier
ds_read_b64 v[40:41], v7 offset:0
ds_read_b64 v[42:43], v7 offset:16
ds_read_b64 v[44:45], v7 offset:32
ds_read_b64 v[46:47], v7 offset:48
s_waitcnt lgkmcnt(0)
s_atomic_add s10, s[52:53], s6 glc
v_max3_f32 v10, v40, v42, v44
v_max3_f32 v10, v10, v46, v6
v_sub_f32 v48, v40, v10
v_sub_f32 v49, v42, v10
v_sub_f32 v50, v44, v10
v_sub_f32 v51, v46, v10
v_sub_f32 v52, v6, v10
v_mul_f32 v48, s49, v48
v_mul_f32 v49, s49, v49
v_mul_f32 v50, s49, v50
v_mul_f32 v51, s49, v51
v_mul_f32 v52, s49, v52
v_exp_f32 v48, v48
v_exp_f32 v49, v49
v_exp_f32 v50, v50
v_exp_f32 v51, v51
v_exp_f32 v52, v52
s_nop 0
v_fma_f32 v11, v48, v41, v52
v_fmac_f32 v11, v49, v43
v_fmac_f32 v11, v50, v45
v_fmac_f32 v11, v51, v47
v_min_u32 v10, s56, v10
v_min_u32 v11, s56, v11
s_mov_b32 exec_lo, 1
s_mov_b32 exec_hi, 1
buffer_store_dwordx2 v[10:11], v7, s[28:31], s50 offen offset:2048
s_mov_b64 exec, -1
v_mul_f32 v12, v52, v32
v_mul_f32 v13, v52, v33
v_mul_f32 v14, v52, v34
v_mul_f32 v15, v52, v35
v_mul_f32 v16, v52, v36
v_mul_f32 v17, v52, v37
v_mul_f32 v18, v52, v38
v_mul_f32 v19, v52, v39
s_waitcnt lgkmcnt(0)
s_mov_b32 s51, s10
s_and_b32 s10, s51, 0xfffff
s_or_b32 s10, s10, s11
s_and_b32 s51, s51, 0xfcf00000
s_cmp_eq_u32 s51, 0x300000
s_cbranch_scc1 L_last
s_barrier
ds_read_b128 v[64:67], v4 offset:128
ds_read_b128 v[68:71], v4 offset:1152
ds_read_b128 v[72:75], v4 offset:2176
ds_read_b128 v[76:79], v4 offset:3200
ds_read_b128 v[80:83], v4 offset:4224
ds_read_b128 v[84:87], v4 offset:5248
ds_read_b128 v[88:91], v4 offset:6272
ds_read_b128 v[92:95], v4 offset:7296
s_waitcnt lgkmcnt(6)
v_pk_fma_f32 v[12:13], v[48:49], v[64:65], v[12:13] op_sel_hi:[0,1,1]
v_pk_fma_f32 v[14:15], v[48:49], v[66:67], v[14:15] op_sel_hi:[0,1,1]
v_pk_fma_f32 v[16:17], v[48:49], v[68:69], v[16:17] op_sel_hi:[0,1,1]
v_pk_fma_f32 v[18:19], v[48:49], v[70:71], v[18:19] op_sel_hi:[0,1,1]
s_waitcnt lgkmcnt(4)
v_pk_fma_f32 v[12:13], v[48:49], v[72:73], v[12:13] op_sel:[1,0,0] op_sel_hi:[1,1,1]
v_pk_fma_f32 v[14:15], v[48:49], v[74:75], v[14:15] op_sel:[1,0,0] op_sel_hi:[1,1,1]
v_pk_fma_f32 v[16:17], v[48:49], v[76:77], v[16:17] op_sel:[1,0,0] op_sel_hi:[1,1,1]
v_pk_fma_f32 v[18:19], v[48:49], v[78:79], v[18:19] op_sel:[1,0,0] op_sel_hi:[1,1,1]
s_waitcnt lgkmcnt(2)
v_pk_fma_f32 v[12:13], v[50:51], v[80:81], v[12:13] op_sel_hi:[0,1,1]
v_pk_fma_f32 v[14:15], v[50:51], v[82:83], v[14:15] op_sel_hi:[0,1,1]
v_pk_fma_f32 v[16:17], v[50:51], v[84:85], v[16:17] op_sel_hi:[0,1,1]
v_pk_fma_f32 v[18:19], v[50:51], v[86:87], v[18:19] op_sel_hi:[0,1,1]
s_waitcnt lgkmcnt(0)
v_pk_fma_f32 v[12:13], v[50:51], v[88:89], v[12:13] op_sel:[1,0,0] op_sel_hi:[1,1,1]
v_pk_fma_f32 v[14:15], v[50:51], v[90:91], v[14:15] op_sel:[1,0,0] op_sel_hi:[1,1,1]
v_pk_fma_f32 v[16:17], v[50:51], v[92:93], v[16:17] op_sel:[1,0,0] op_sel_hi:[1,1,1]
v_pk_fma_f32 v[18:19], v[50:51], v[94:95], v[18:19] op_sel:[1,0,0] op_sel_hi:[1,1,1]
v_min_u32 v12, s56, v12
v_min_u32 v13, s56, v13
v_min_u32 v14, s56, v14
v_min_u32 v15, s56, v15
buffer_store_dwordx4 v[12:15], v4, s[28:31], s50 offen
v_min_u32 v16, s56, v16
v_min_u32 v17, s56, v17
v_min_u32 v18, s56, v18
v_min_u32 v19, s56, v19
buffer_store_dwordx4 v[16:19], v4, s[28:31], s50 offen offset:1024
s_mov_b32 s10, 0
s_atomic_add s10, s[52:53], s6 glc
s_waitcnt lgkmcnt(0)
s_and_b32 s10, s10, 0xfffff
s_cmp_eq_u32 s10, s8
s_cbranch_scc1 L_done
s_add_u32 s50, s50, 0x100000
buffer_store_dwordx4 v[12:15], v4, s[28:31], s50 offen sc1
buffer_store_dwordx4 v[16:19], v4, s[28:31], s50 offen offset:1024 sc1
s_mov_b32 exec_lo, 1
s_mov_b32 exec_hi, 1
buffer_store_dwordx2 v[10:11], v7, s[28:31], s50 offen offset:2048 sc1
s_mov_b64 exec, 1
v_mov_b32 v9, 0x1000000
s_waitcnt vmcnt(0)
global_atomic_add v8, v9, s[52:53]
s_endpgm
L_last:
s_cmp_eq_u32 s10, s8
s_cbranch_scc1 L_comb
L_wait:
global_load_dword v28, v8, s[52:53] sc1
s_waitcnt vmcnt(0)
v_readfirstlane_b32 s51, v28
s_sub_u32 s5, s5, 1
s_cbranch_scc1 L_wend
s_bfe_u32 s51, s51, 0x30018
s_cmp_lg_u32 s51, 3
s_cbranch_scc1 L_wait
L_wend:
s_add_u32 s57, s57, 0x100000
s_add_u32 s58, s58, 0x100000
s_add_u32 s59, s59, 0x100000
s_mov_b32 s5, 0x100000
L_comb:
buffer_load_dwordx2 v[104:105], v7, s[28:31], s57 offen offset:2048 sc1
buffer_load_dwordx2 v[116:117], v7, s[28:31], s58 offen offset:2048 sc1
buffer_load_dwordx2 v[128:129], v7, s[28:31], s59 offen offset:2048 sc1
buffer_load_dwordx4 v[96:99], v4, s[28:31], s57 offen sc1
buffer_load_dwordx4 v[100:103], v4, s[28:31], s57 offen offset:1024 sc1
buffer_load_dwordx4 v[108:111], v4, s[28:31], s58 offen sc1
buffer_load_dwordx4 v[112:115], v4, s[28:31], s58 offen offset:1024 sc1
buffer_load_dwordx4 v[120:123], v4, s[28:31], s59 offen sc1
buffer_load_dwordx4 v[124:127], v4, s[28:31], s59 offen offset:1024 sc1
s_waitcnt vmcnt(6)
v_max3_u32 v28, v104, v105, v116
v_max3_u32 v28, v117, v128, v28
v_max_u32 v28, v129, v28
v_cmp_eq_u32 vcc, -1, v28
s_sub_u32 s5, s5, 1
s_cbranch_scc1 L_mlok
s_cbranch_vccnz L_comb
L_mlok:
v_max3_f32 v28, v10, v104, v116
v_max_f32 v28, v28, v128
v_sub_f32 v52, v10, v28
v_sub_f32 v53, v104, v28
v_sub_f32 v54, v116, v28
v_sub_f32 v55, v128, v28
v_mul_f32 v52, s49, v52
v_mul_f32 v53, s49, v53
v_mul_f32 v54, s49, v54
v_mul_f32 v55, s49, v55
v_exp_f32 v52, v52
v_exp_f32 v53, v53
v_exp_f32 v54, v54
v_exp_f32 v55, v55
v_mul_f32 v29, v52, v11
v_fmac_f32 v29, v53, v105
v_fmac_f32 v29, v54, v117
v_fmac_f32 v29, v55, v129
v_rcp_f32 v29, v29
s_nop 0
v_mul_f32 v52, v52, v29
v_mul_f32 v53, v53, v29
v_mul_f32 v54, v54, v29
v_mul_f32 v55, v55, v29
v_mul_f32 v48, v48, v52
v_mul_f32 v49, v49, v52
v_mul_f32 v50, v50, v52
v_mul_f32 v51, v51, v52
v_mul_f32 v12, v52, v12
v_mul_f32 v13, v52, v13
v_mul_f32 v14, v52, v14
v_mul_f32 v15, v52, v15
v_mul_f32 v16, v52, v16
v_mul_f32 v17, v52, v17
v_mul_f32 v18, v52, v18
v_mul_f32 v19, v52, v19
s_mov_b32 s5, 0x100000
s_waitcnt vmcnt(4)
v_max_u32 v28, v96, v97
v_max3_u32 v28, v98, v99, v28
v_max3_u32 v28, v100, v101, v28
v_max3_u32 v28, v102, v103, v28
s_waitcnt vmcnt(2)
v_max3_u32 v28, v108, v109, v28
v_max3_u32 v28, v110, v111, v28
v_max3_u32 v28, v112, v113, v28
v_max3_u32 v28, v114, v115, v28
s_waitcnt vmcnt(0)
v_max3_u32 v28, v120, v121, v28
v_max3_u32 v28, v122, v123, v28
v_max3_u32 v28, v124, v125, v28
v_max3_u32 v28, v126, v127, v28
v_cmp_eq_u32 vcc, -1, v28
s_cbranch_vccnz L_late
L_early:
v_pk_fma_f32 v[12:13], v[52:53], v[96:97], v[12:13] op_sel:[1,0,0] op_sel_hi:[1,1,1]
v_pk_fma_f32 v[14:15], v[52:53], v[98:99], v[14:15] op_sel:[1,0,0] op_sel_hi:[1,1,1]
v_pk_fma_f32 v[16:17], v[52:53], v[100:101], v[16:17] op_sel:[1,0,0] op_sel_hi:[1,1,1]
v_pk_fma_f32 v[18:19], v[52:53], v[102:103], v[18:19] op_sel:[1,0,0] op_sel_hi:[1,1,1]
v_pk_fma_f32 v[12:13], v[54:55], v[108:109], v[12:13] op_sel_hi:[0,1,1]
v_pk_fma_f32 v[14:15], v[54:55], v[110:111], v[14:15] op_sel_hi:[0,1,1]
v_pk_fma_f32 v[16:17], v[54:55], v[112:113], v[16:17] op_sel_hi:[0,1,1]
v_pk_fma_f32 v[18:19], v[54:55], v[114:115], v[18:19] op_sel_hi:[0,1,1]
v_pk_fma_f32 v[12:13], v[54:55], v[120:121], v[12:13] op_sel:[1,0,0] op_sel_hi:[1,1,1]
v_pk_fma_f32 v[14:15], v[54:55], v[122:123], v[14:15] op_sel:[1,0,0] op_sel_hi:[1,1,1]
v_pk_fma_f32 v[16:17], v[54:55], v[124:125], v[16:17] op_sel:[1,0,0] op_sel_hi:[1,1,1]
v_pk_fma_f32 v[18:19], v[54:55], v[126:127], v[18:19] op_sel:[1,0,0] op_sel_hi:[1,1,1]
s_barrier
ds_read_b128 v[64:67], v4 offset:128
ds_read_b128 v[68:71], v4 offset:1152
ds_read_b128 v[72:75], v4 offset:2176
ds_read_b128 v[76:79], v4 offset:3200
ds_read_b128 v[80:83], v4 offset:4224
ds_read_b128 v[84:87], v4 offset:5248
ds_read_b128 v[88:91], v4 offset:6272
ds_read_b128 v[92:95], v4 offset:7296
s_waitcnt lgkmcnt(6)
v_pk_fma_f32 v[12:13], v[48:49], v[64:65], v[12:13] op_sel_hi:[0,1,1]
v_pk_fma_f32 v[14:15], v[48:49], v[66:67], v[14:15] op_sel_hi:[0,1,1]
v_pk_fma_f32 v[16:17], v[48:49], v[68:69], v[16:17] op_sel_hi:[0,1,1]
v_pk_fma_f32 v[18:19], v[48:49], v[70:71], v[18:19] op_sel_hi:[0,1,1]
s_waitcnt lgkmcnt(4)
v_pk_fma_f32 v[12:13], v[48:49], v[72:73], v[12:13] op_sel:[1,0,0] op_sel_hi:[1,1,1]
v_pk_fma_f32 v[14:15], v[48:49], v[74:75], v[14:15] op_sel:[1,0,0] op_sel_hi:[1,1,1]
v_pk_fma_f32 v[16:17], v[48:49], v[76:77], v[16:17] op_sel:[1,0,0] op_sel_hi:[1,1,1]
v_pk_fma_f32 v[18:19], v[48:49], v[78:79], v[18:19] op_sel:[1,0,0] op_sel_hi:[1,1,1]
s_waitcnt lgkmcnt(2)
v_pk_fma_f32 v[12:13], v[50:51], v[80:81], v[12:13] op_sel_hi:[0,1,1]
v_pk_fma_f32 v[14:15], v[50:51], v[82:83], v[14:15] op_sel_hi:[0,1,1]
v_pk_fma_f32 v[16:17], v[50:51], v[84:85], v[16:17] op_sel_hi:[0,1,1]
v_pk_fma_f32 v[18:19], v[50:51], v[86:87], v[18:19] op_sel_hi:[0,1,1]
s_waitcnt lgkmcnt(0)
v_pk_fma_f32 v[12:13], v[50:51], v[88:89], v[12:13] op_sel:[1,0,0] op_sel_hi:[1,1,1]
v_pk_fma_f32 v[14:15], v[50:51], v[90:91], v[14:15] op_sel:[1,0,0] op_sel_hi:[1,1,1]
v_pk_fma_f32 v[16:17], v[50:51], v[92:93], v[16:17] op_sel:[1,0,0] op_sel_hi:[1,1,1]
v_pk_fma_f32 v[18:19], v[50:51], v[94:95], v[18:19] op_sel:[1,0,0] op_sel_hi:[1,1,1]
s_branch L_out
L_late:
s_barrier
buffer_load_dwordx4 v[96:99], v4, s[28:31], s57 offen sc1
buffer_load_dwordx4 v[100:103], v4, s[28:31], s57 offen offset:1024 sc1
buffer_load_dwordx4 v[108:111], v4, s[28:31], s58 offen sc1
buffer_load_dwordx4 v[112:115], v4, s[28:31], s58 offen offset:1024 sc1
buffer_load_dwordx4 v[120:123], v4, s[28:31], s59 offen sc1
buffer_load_dwordx4 v[124:127], v4, s[28:31], s59 offen offset:1024 sc1
ds_read_b128 v[64:67], v4 offset:128
ds_read_b128 v[68:71], v4 offset:1152
ds_read_b128 v[72:75], v4 offset:2176
ds_read_b128 v[76:79], v4 offset:3200
ds_read_b128 v[80:83], v4 offset:4224
ds_read_b128 v[84:87], v4 offset:5248
ds_read_b128 v[88:91], v4 offset:6272
ds_read_b128 v[92:95], v4 offset:7296
s_waitcnt lgkmcnt(6)
v_pk_fma_f32 v[12:13], v[48:49], v[64:65], v[12:13] op_sel_hi:[0,1,1]
v_pk_fma_f32 v[14:15], v[48:49], v[66:67], v[14:15] op_sel_hi:[0,1,1]
v_pk_fma_f32 v[16:17], v[48:49], v[68:69], v[16:17] op_sel_hi:[0,1,1]
v_pk_fma_f32 v[18:19], v[48:49], v[70:71], v[18:19] op_sel_hi:[0,1,1]
s_waitcnt lgkmcnt(4)
v_pk_fma_f32 v[12:13], v[48:49], v[72:73], v[12:13] op_sel:[1,0,0] op_sel_hi:[1,1,1]
v_pk_fma_f32 v[14:15], v[48:49], v[74:75], v[14:15] op_sel:[1,0,0] op_sel_hi:[1,1,1]
v_pk_fma_f32 v[16:17], v[48:49], v[76:77], v[16:17] op_sel:[1,0,0] op_sel_hi:[1,1,1]
v_pk_fma_f32 v[18:19], v[48:49], v[78:79], v[18:19] op_sel:[1,0,0] op_sel_hi:[1,1,1]
s_waitcnt lgkmcnt(2)
v_pk_fma_f32 v[12:13], v[50:51], v[80:81], v[12:13] op_sel_hi:[0,1,1]
v_pk_fma_f32 v[14:15], v[50:51], v[82:83], v[14:15] op_sel_hi:[0,1,1]
v_pk_fma_f32 v[16:17], v[50:51], v[84:85], v[16:17] op_sel_hi:[0,1,1]
v_pk_fma_f32 v[18:19], v[50:51], v[86:87], v[18:19] op_sel_hi:[0,1,1]
s_waitcnt lgkmcnt(0)
v_pk_fma_f32 v[12:13], v[50:51], v[88:89], v[12:13] op_sel:[1,0,0] op_sel_hi:[1,1,1]
v_pk_fma_f32 v[14:15], v[50:51], v[90:91], v[14:15] op_sel:[1,0,0] op_sel_hi:[1,1,1]
v_pk_fma_f32 v[16:17], v[50:51], v[92:93], v[16:17] op_sel:[1,0,0] op_sel_hi:[1,1,1]
v_pk_fma_f32 v[18:19], v[50:51], v[94:95], v[18:19] op_sel:[1,0,0] op_sel_hi:[1,1,1]
L_poll:
s_waitcnt vmcnt(4)
v_max_u32 v28, v96, v97
v_max3_u32 v28, v98, v99, v28
v_max3_u32 v28, v100, v101, v28
v_max3_u32 v28, v102, v103, v28
s_waitcnt vmcnt(2)
v_max3_u32 v28, v108, v109, v28
v_max3_u32 v28, v110, v111, v28
v_max3_u32 v28, v112, v113, v28
v_max3_u32 v28, v114, v115, v28
s_waitcnt vmcnt(0)
v_max3_u32 v28, v120, v121, v28
v_max3_u32 v28, v122, v123, v28
v_max3_u32 v28, v124, v125, v28
v_max3_u32 v28, v126, v127, v28
v_cmp_eq_u32 vcc, -1, v28
s_cbranch_vccz L_got
buffer_load_dwordx4 v[96:99], v4, s[28:31], s57 offen sc1
buffer_load_dwordx4 v[100:103], v4, s[28:31], s57 offen offset:1024 sc1
buffer_load_dwordx4 v[108:111], v4, s[28:31], s58 offen sc1
buffer_load_dwordx4 v[112:115], v4, s[28:31], s58 offen offset:1024 sc1
buffer_load_dwordx4 v[120:123], v4, s[28:31], s59 offen sc1
buffer_load_dwordx4 v[124:127], v4, s[28:31], s59 offen offset:1024 sc1
s_sub_u32 s5, s5, 1
s_cbranch_scc0 L_poll
s_waitcnt vmcnt(0)
L_got:
v_pk_fma_f32 v[12:13], v[52:53], v[96:97], v[12:13] op_sel:[1,0,0] op_sel_hi:[1,1,1]
v_pk_fma_f32 v[14:15], v[52:53], v[98:99], v[14:15] op_sel:[1,0,0] op_sel_hi:[1,1,1]
v_pk_fma_f32 v[16:17], v[52:53], v[100:101], v[16:17] op_sel:[1,0,0] op_sel_hi:[1,1,1]
v_pk_fma_f32 v[18:19], v[52:53], v[102:103], v[18:19] op_sel:[1,0,0] op_sel_hi:[1,1,1]
v_pk_fma_f32 v[12:13], v[54:55], v[108:109], v[12:13] op_sel_hi:[0,1,1]
v_pk_fma_f32 v[14:15], v[54:55], v[110:111], v[14:15] op_sel_hi:[0,1,1]
v_pk_fma_f32 v[16:17], v[54:55], v[112:113], v[16:17] op_sel_hi:[0,1,1]
v_pk_fma_f32 v[18:19], v[54:55], v[114:115], v[18:19] op_sel_hi:[0,1,1]
v_pk_fma_f32 v[12:13], v[54:55], v[120:121], v[12:13] op_sel:[1,0,0] op_sel_hi:[1,1,1]
v_pk_fma_f32 v[14:15], v[54:55], v[122:123], v[14:15] op_sel:[1,0,0] op_sel_hi:[1,1,1]
v_pk_fma_f32 v[16:17], v[54:55], v[124:125], v[16:17] op_sel:[1,0,0] op_sel_hi:[1,1,1]
v_pk_fma_f32 v[18:19], v[54:55], v[126:127], v[18:19] op_sel:[1,0,0] op_sel_hi:[1,1,1]
L_out:
v_cvt_pk_bf16_f32 v24, v12, v13
v_cvt_pk_bf16_f32 v25, v14, v15
v_cvt_pk_bf16_f32 v26, v16, v17
v_cvt_pk_bf16_f32 v27, v18, v19
buffer_store_dwordx4 v[24:27], v4, s[40:43], s7 offen
L_done:
s_endpgm
.section .rodata,"a"
.p2align 6
.amdhsa_kernel standalone__tree_speculative_verify_tree_attention_over_candidate_token_tree__decode_kernel
  .amdhsa_next_free_vgpr 188
  .amdhsa_next_free_sgpr 80
  .amdhsa_accum_offset 188
  .amdhsa_group_segment_fixed_size 0
  .amdhsa_kernarg_size 72
  .amdhsa_user_sgpr_count 2
  .amdhsa_user_sgpr_kernarg_segment_ptr 1
  .amdhsa_system_sgpr_workgroup_id_x 1
  .amdhsa_float_denorm_mode_32 3
.end_amdhsa_kernel
```
